```python
import torch

def _softmax(x, axis=-1):
    return torch.softmax(x, dim=axis)

def _gelu(x):
    return torch.nn.functional.gelu(x, approximate='tanh')

def _silu(x):
    return torch.nn.functional.silu(x)

def _sigmoid(x):
    return torch.sigmoid(x)

def _layernorm(x, axis=-1, eps=1e-05):
    m = x.mean(dim=axis, keepdim=True)
    v = x.var(dim=axis, keepdim=True, unbiased=False)
    return (x - m) / torch.sqrt(v + eps)

def _scatter_add(tgt, idx, src, axis=0):
    return tgt.clone().index_add_(axis, idx, src)

def _segment_sum(src, seg, n):
    out = torch.zeros((n,) + src.shape[1:], dtype=src.dtype)
    return out.index_add_(0, seg, src)

def _pad(x, pw):
    flat = tuple((v for pair in reversed(pw) for v in pair))
    return torch.nn.functional.pad(x, flat)
kernel_name = 'parallel_sum__memory_aug_recurrent_mem_tr__glu_gated_geglu__prompt'

def setup_inputs():

    _w = lambda a: (lambda t: t.to(torch.bfloat16) if t.is_floating_point() else t)(torch.as_tensor(a))

    def _A_setup():
        B, S, Dm = (1, 2048, 640)
        H, Dh = (32, 128)
        M, seg = (8, 32)
        seg = min(seg, S)
        S = S // seg * seg
        return {'x': _w((lambda *s: torch.randn(*s, dtype=torch.bfloat16) * 0.05)(B, S, Dm)), 'mem0': _w((lambda *s: torch.randn(*s, dtype=torch.bfloat16) * 0.2)(B, M, Dm)), 'Wq': _w((lambda *s: torch.randn(*s, dtype=torch.bfloat16) * 1.6)(Dm, H, Dh) * Dm ** (-0.5)), 'Wk': _w((lambda *s: torch.randn(*s, dtype=torch.bfloat16) * 1.6)(Dm, H, Dh) * Dm ** (-0.5)), 'Wv': _w((lambda *s: torch.randn(*s, dtype=torch.bfloat16) * 0.2)(Dm, H, Dh) * Dm ** (-0.5)), 'Wo': _w((lambda *s: torch.randn(*s, dtype=torch.bfloat16) * 0.2)(H, Dh, Dm) * (H * Dh) ** (-0.5)), 'seg_len': seg}
    _A_in = _A_setup()

    def _B_setup():
        B, S, Dm, Df = (1, 2048, 640, 1728)
        return {'x': _w((lambda *s: torch.randn(*s, dtype=torch.bfloat16) * 0.05)(B, S, Dm)), 'w_gate': _w((lambda *s: torch.randn(*s, dtype=torch.bfloat16) * 0.4)(Dm, Df) * Dm ** (-0.5)), 'w_up': _w((lambda *s: torch.randn(*s, dtype=torch.bfloat16) * 0.4)(Dm, Df) * Dm ** (-0.5)), 'w_down': _w((lambda *s: torch.randn(*s, dtype=torch.bfloat16) * 0.4)(Df, Dm) * Df ** (-0.5))}
    _B_in = _B_setup()
    return {'A_x': _A_in['x'], 'A_mem0': _A_in['mem0'], 'A_Wq': _A_in['Wq'], 'A_Wk': _A_in['Wk'], 'A_Wv': _A_in['Wv'], 'A_Wo': _A_in['Wo'], 'A_seg_len': _A_in['seg_len'], 'B_x': _B_in['x'], 'B_w_gate': _B_in['w_gate'], 'B_w_up': _B_in['w_up'], 'B_w_down': _B_in['w_down']}

def reference(A_x, A_mem0, A_Wq, A_Wk, A_Wv, A_Wo, A_seg_len, B_x, B_w_gate, B_w_up, B_w_down):

    def _A_ref(x, mem0, Wq, Wk, Wv, Wo, seg_len):
        B, S, Dm = x.shape
        H, Dh = (Wq.shape[1], Wq.shape[2])
        M = mem0.shape[1]
        scale = Dh ** (-0.5)
        n_seg = S // seg_len
        L = M + seg_len
        idx = torch.arange(L)
        mask = (idx[:, None] < M) | (idx[:, None] >= idx[None, :])
        mem = mem0
        outs = []
        for s in range(n_seg):
            xs = x[:, s * seg_len:(s + 1) * seg_len, :].clone()
            h = torch.concatenate([mem, xs], axis=1)
            q = torch.einsum('btd,dhe->bhte', h, Wq)
            k = torch.einsum('btd,dhe->bhte', h, Wk)
            v = torch.einsum('btd,dhe->bhte', h, Wv)
            scores = torch.einsum('bhqe,bhke->bhqk', q, k) * scale
            scores = torch.where(mask[None, None], scores, -1000000000.0)
            p = _softmax(scores, axis=-1)
            o = torch.einsum('bhqk,bhke->bhqe', p, v)
            o = torch.einsum('bhte,hed->btd', o, Wo)
            mem = o[:, :M, :].clone()
            outs.append(o[:, M:, :])
        return torch.concatenate(outs, axis=1)

    def _B_ref(x, w_gate, w_up, w_down):
        g = torch.einsum('bsd,df->bsf', x, w_gate)
        u = torch.einsum('bsd,df->bsf', x, w_up)
        h = _gelu(g) * u
        return torch.einsum('bsf,fd->bsd', h, w_down)
    x = A_x
    xn = _layernorm(x, axis=-1)
    return x + _A_ref(xn, A_mem0, A_Wq, A_Wk, A_Wv, A_Wo, A_seg_len) + _B_ref(xn, B_w_gate, B_w_up, B_w_down)
```

```asm
; @launch kernel=prep_kernel grid=(1488,1,1) block=(256,1,1) lds=16384
; @launch kernel=rec_kernel grid=(256,1,1) block=(256,1,1) lds=163840
.amdgcn_target "amdgcn-amd-amdhsa--gfx950"
.text
.globl prep_kernel
.p2align 8
.type prep_kernel,@function
prep_kernel:
    s_load_dwordx2 s[4:5], s[0:1], 104
    s_mov_b32 s6, 268435456
    s_mov_b32 s7, 0x00020000
    v_lshrrev_b32 v1, 6, v0
    s_nop 0
    v_readfirstlane_b32 s3, v1
    v_and_b32 v1, 63, v0
    s_cmp_ge_u32 s2, 1488
    s_cbranch_scc1 prep_end
    s_cmp_ge_u32 s2, 128
    s_cbranch_scc1 prep_noln
    s_load_dwordx2 s[8:9], s[0:1], 0
    s_mov_b32 s10, 2621440
    s_mov_b32 s11, 0x00020000
    s_setprio 3
    s_cmp_ge_u32 s3, 1
    s_cbranch_scc1 prep_end
    s_mul_i32 s20, s2, 1
    s_add_u32 s20, s20, s3
    s_waitcnt lgkmcnt(0)
    v_and_b32 v2, 15, v1
    v_lshrrev_b32 v3, 4, v1
    s_mul_i32 s21, s20, 20480
    v_mul_u32_u24 v2, 1280, v2
    v_lshrrev_b32 v4, 1, v3
    v_and_b32 v3, 1, v3
    v_lshl_add_u32 v2, v4, 5, v2
    v_lshl_add_u32 v2, v3, 3, v2
    v_lshlrev_b32 v5, 4, v1
    buffer_load_dwordx2 v[16:17], v2, s[8:11], s21 offen offset:0
    buffer_load_dwordx2 v[18:19], v2, s[8:11], s21 offen offset:16
    buffer_load_dwordx2 v[20:21], v2, s[8:11], s21 offen offset:64
    buffer_load_dwordx2 v[22:23], v2, s[8:11], s21 offen offset:80
    buffer_load_dwordx2 v[24:25], v2, s[8:11], s21 offen offset:128
    buffer_load_dwordx2 v[26:27], v2, s[8:11], s21 offen offset:144
    buffer_load_dwordx2 v[28:29], v2, s[8:11], s21 offen offset:192
    buffer_load_dwordx2 v[30:31], v2, s[8:11], s21 offen offset:208
    buffer_load_dwordx2 v[32:33], v2, s[8:11], s21 offen offset:256
    buffer_load_dwordx2 v[34:35], v2, s[8:11], s21 offen offset:272
    buffer_load_dwordx2 v[36:37], v2, s[8:11], s21 offen offset:320
    buffer_load_dwordx2 v[38:39], v2, s[8:11], s21 offen offset:336
    buffer_load_dwordx2 v[40:41], v2, s[8:11], s21 offen offset:384
    buffer_load_dwordx2 v[42:43], v2, s[8:11], s21 offen offset:400
    buffer_load_dwordx2 v[44:45], v2, s[8:11], s21 offen offset:448
    buffer_load_dwordx2 v[46:47], v2, s[8:11], s21 offen offset:464
    buffer_load_dwordx2 v[48:49], v2, s[8:11], s21 offen offset:512
    buffer_load_dwordx2 v[50:51], v2, s[8:11], s21 offen offset:528
    buffer_load_dwordx2 v[52:53], v2, s[8:11], s21 offen offset:576
    buffer_load_dwordx2 v[54:55], v2, s[8:11], s21 offen offset:592
    buffer_load_dwordx2 v[56:57], v2, s[8:11], s21 offen offset:640
    buffer_load_dwordx2 v[58:59], v2, s[8:11], s21 offen offset:656
    buffer_load_dwordx2 v[60:61], v2, s[8:11], s21 offen offset:704
    buffer_load_dwordx2 v[62:63], v2, s[8:11], s21 offen offset:720
    buffer_load_dwordx2 v[64:65], v2, s[8:11], s21 offen offset:768
    buffer_load_dwordx2 v[66:67], v2, s[8:11], s21 offen offset:784
    buffer_load_dwordx2 v[68:69], v2, s[8:11], s21 offen offset:832
    buffer_load_dwordx2 v[70:71], v2, s[8:11], s21 offen offset:848
    buffer_load_dwordx2 v[72:73], v2, s[8:11], s21 offen offset:896
    buffer_load_dwordx2 v[74:75], v2, s[8:11], s21 offen offset:912
    buffer_load_dwordx2 v[76:77], v2, s[8:11], s21 offen offset:960
    buffer_load_dwordx2 v[78:79], v2, s[8:11], s21 offen offset:976
    buffer_load_dwordx2 v[80:81], v2, s[8:11], s21 offen offset:1024
    buffer_load_dwordx2 v[82:83], v2, s[8:11], s21 offen offset:1040
    buffer_load_dwordx2 v[84:85], v2, s[8:11], s21 offen offset:1088
    buffer_load_dwordx2 v[86:87], v2, s[8:11], s21 offen offset:1104
    buffer_load_dwordx2 v[88:89], v2, s[8:11], s21 offen offset:1152
    buffer_load_dwordx2 v[90:91], v2, s[8:11], s21 offen offset:1168
    buffer_load_dwordx2 v[92:93], v2, s[8:11], s21 offen offset:1216
    buffer_load_dwordx2 v[94:95], v2, s[8:11], s21 offen offset:1232
    s_mov_b32 s22, 0xffff0000
    v_mov_b32 v6, 0
    v_mov_b32 v7, 0
    s_waitcnt vmcnt(0)
    v_lshlrev_b32 v8, 16, v16
    v_and_b32 v9, s22, v16
    v_add_f32 v6, v6, v8
    v_add_f32 v7, v7, v9
    v_lshlrev_b32 v8, 16, v17
    v_and_b32 v9, s22, v17
    v_add_f32 v6, v6, v8
    v_add_f32 v7, v7, v9
    v_lshlrev_b32 v8, 16, v18
    v_and_b32 v9, s22, v18
    v_add_f32 v6, v6, v8
    v_add_f32 v7, v7, v9
    v_lshlrev_b32 v8, 16, v19
    v_and_b32 v9, s22, v19
    v_add_f32 v6, v6, v8
    v_add_f32 v7, v7, v9
    v_lshlrev_b32 v8, 16, v20
    v_and_b32 v9, s22, v20
    v_add_f32 v6, v6, v8
    v_add_f32 v7, v7, v9
    v_lshlrev_b32 v8, 16, v21
    v_and_b32 v9, s22, v21
    v_add_f32 v6, v6, v8
    v_add_f32 v7, v7, v9
    v_lshlrev_b32 v8, 16, v22
    v_and_b32 v9, s22, v22
    v_add_f32 v6, v6, v8
    v_add_f32 v7, v7, v9
    v_lshlrev_b32 v8, 16, v23
    v_and_b32 v9, s22, v23
    v_add_f32 v6, v6, v8
    v_add_f32 v7, v7, v9
    v_lshlrev_b32 v8, 16, v24
    v_and_b32 v9, s22, v24
    v_add_f32 v6, v6, v8
    v_add_f32 v7, v7, v9
    v_lshlrev_b32 v8, 16, v25
    v_and_b32 v9, s22, v25
    v_add_f32 v6, v6, v8
    v_add_f32 v7, v7, v9
    v_lshlrev_b32 v8, 16, v26
    v_and_b32 v9, s22, v26
    v_add_f32 v6, v6, v8
    v_add_f32 v7, v7, v9
    v_lshlrev_b32 v8, 16, v27
    v_and_b32 v9, s22, v27
    v_add_f32 v6, v6, v8
    v_add_f32 v7, v7, v9
    v_lshlrev_b32 v8, 16, v28
    v_and_b32 v9, s22, v28
    v_add_f32 v6, v6, v8
    v_add_f32 v7, v7, v9
    v_lshlrev_b32 v8, 16, v29
    v_and_b32 v9, s22, v29
    v_add_f32 v6, v6, v8
    v_add_f32 v7, v7, v9
    v_lshlrev_b32 v8, 16, v30
    v_and_b32 v9, s22, v30
    v_add_f32 v6, v6, v8
    v_add_f32 v7, v7, v9
    v_lshlrev_b32 v8, 16, v31
    v_and_b32 v9, s22, v31
    v_add_f32 v6, v6, v8
    v_add_f32 v7, v7, v9
    v_lshlrev_b32 v8, 16, v32
    v_and_b32 v9, s22, v32
    v_add_f32 v6, v6, v8
    v_add_f32 v7, v7, v9
    v_lshlrev_b32 v8, 16, v33
    v_and_b32 v9, s22, v33
    v_add_f32 v6, v6, v8
    v_add_f32 v7, v7, v9
    v_lshlrev_b32 v8, 16, v34
    v_and_b32 v9, s22, v34
    v_add_f32 v6, v6, v8
    v_add_f32 v7, v7, v9
    v_lshlrev_b32 v8, 16, v35
    v_and_b32 v9, s22, v35
    v_add_f32 v6, v6, v8
    v_add_f32 v7, v7, v9
    v_lshlrev_b32 v8, 16, v36
    v_and_b32 v9, s22, v36
    v_add_f32 v6, v6, v8
    v_add_f32 v7, v7, v9
    v_lshlrev_b32 v8, 16, v37
    v_and_b32 v9, s22, v37
    v_add_f32 v6, v6, v8
    v_add_f32 v7, v7, v9
    v_lshlrev_b32 v8, 16, v38
    v_and_b32 v9, s22, v38
    v_add_f32 v6, v6, v8
    v_add_f32 v7, v7, v9
    v_lshlrev_b32 v8, 16, v39
    v_and_b32 v9, s22, v39
    v_add_f32 v6, v6, v8
    v_add_f32 v7, v7, v9
    v_lshlrev_b32 v8, 16, v40
    v_and_b32 v9, s22, v40
    v_add_f32 v6, v6, v8
    v_add_f32 v7, v7, v9
    v_lshlrev_b32 v8, 16, v41
    v_and_b32 v9, s22, v41
    v_add_f32 v6, v6, v8
    v_add_f32 v7, v7, v9
    v_lshlrev_b32 v8, 16, v42
    v_and_b32 v9, s22, v42
    v_add_f32 v6, v6, v8
    v_add_f32 v7, v7, v9
    v_lshlrev_b32 v8, 16, v43
    v_and_b32 v9, s22, v43
    v_add_f32 v6, v6, v8
    v_add_f32 v7, v7, v9
    v_lshlrev_b32 v8, 16, v44
    v_and_b32 v9, s22, v44
    v_add_f32 v6, v6, v8
    v_add_f32 v7, v7, v9
    v_lshlrev_b32 v8, 16, v45
    v_and_b32 v9, s22, v45
    v_add_f32 v6, v6, v8
    v_add_f32 v7, v7, v9
    v_lshlrev_b32 v8, 16, v46
    v_and_b32 v9, s22, v46
    v_add_f32 v6, v6, v8
    v_add_f32 v7, v7, v9
    v_lshlrev_b32 v8, 16, v47
    v_and_b32 v9, s22, v47
    v_add_f32 v6, v6, v8
    v_add_f32 v7, v7, v9
    v_lshlrev_b32 v8, 16, v48
    v_and_b32 v9, s22, v48
    v_add_f32 v6, v6, v8
    v_add_f32 v7, v7, v9
    v_lshlrev_b32 v8, 16, v49
    v_and_b32 v9, s22, v49
    v_add_f32 v6, v6, v8
    v_add_f32 v7, v7, v9
    v_lshlrev_b32 v8, 16, v50
    v_and_b32 v9, s22, v50
    v_add_f32 v6, v6, v8
    v_add_f32 v7, v7, v9
    v_lshlrev_b32 v8, 16, v51
    v_and_b32 v9, s22, v51
    v_add_f32 v6, v6, v8
    v_add_f32 v7, v7, v9
    v_lshlrev_b32 v8, 16, v52
    v_and_b32 v9, s22, v52
    v_add_f32 v6, v6, v8
    v_add_f32 v7, v7, v9
    v_lshlrev_b32 v8, 16, v53
    v_and_b32 v9, s22, v53
    v_add_f32 v6, v6, v8
    v_add_f32 v7, v7, v9
    v_lshlrev_b32 v8, 16, v54
    v_and_b32 v9, s22, v54
    v_add_f32 v6, v6, v8
    v_add_f32 v7, v7, v9
    v_lshlrev_b32 v8, 16, v55
    v_and_b32 v9, s22, v55
    v_add_f32 v6, v6, v8
    v_add_f32 v7, v7, v9
    v_lshlrev_b32 v8, 16, v56
    v_and_b32 v9, s22, v56
    v_add_f32 v6, v6, v8
    v_add_f32 v7, v7, v9
    v_lshlrev_b32 v8, 16, v57
    v_and_b32 v9, s22, v57
    v_add_f32 v6, v6, v8
    v_add_f32 v7, v7, v9
    v_lshlrev_b32 v8, 16, v58
    v_and_b32 v9, s22, v58
    v_add_f32 v6, v6, v8
    v_add_f32 v7, v7, v9
    v_lshlrev_b32 v8, 16, v59
    v_and_b32 v9, s22, v59
    v_add_f32 v6, v6, v8
    v_add_f32 v7, v7, v9
    v_lshlrev_b32 v8, 16, v60
    v_and_b32 v9, s22, v60
    v_add_f32 v6, v6, v8
    v_add_f32 v7, v7, v9
    v_lshlrev_b32 v8, 16, v61
    v_and_b32 v9, s22, v61
    v_add_f32 v6, v6, v8
    v_add_f32 v7, v7, v9
    v_lshlrev_b32 v8, 16, v62
    v_and_b32 v9, s22, v62
    v_add_f32 v6, v6, v8
    v_add_f32 v7, v7, v9
    v_lshlrev_b32 v8, 16, v63
    v_and_b32 v9, s22, v63
    v_add_f32 v6, v6, v8
    v_add_f32 v7, v7, v9
    v_lshlrev_b32 v8, 16, v64
    v_and_b32 v9, s22, v64
    v_add_f32 v6, v6, v8
    v_add_f32 v7, v7, v9
    v_lshlrev_b32 v8, 16, v65
    v_and_b32 v9, s22, v65
    v_add_f32 v6, v6, v8
    v_add_f32 v7, v7, v9
    v_lshlrev_b32 v8, 16, v66
    v_and_b32 v9, s22, v66
    v_add_f32 v6, v6, v8
    v_add_f32 v7, v7, v9
    v_lshlrev_b32 v8, 16, v67
    v_and_b32 v9, s22, v67
    v_add_f32 v6, v6, v8
    v_add_f32 v7, v7, v9
    v_lshlrev_b32 v8, 16, v68
    v_and_b32 v9, s22, v68
    v_add_f32 v6, v6, v8
    v_add_f32 v7, v7, v9
    v_lshlrev_b32 v8, 16, v69
    v_and_b32 v9, s22, v69
    v_add_f32 v6, v6, v8
    v_add_f32 v7, v7, v9
    v_lshlrev_b32 v8, 16, v70
    v_and_b32 v9, s22, v70
    v_add_f32 v6, v6, v8
    v_add_f32 v7, v7, v9
    v_lshlrev_b32 v8, 16, v71
    v_and_b32 v9, s22, v71
    v_add_f32 v6, v6, v8
    v_add_f32 v7, v7, v9
    v_lshlrev_b32 v8, 16, v72
    v_and_b32 v9, s22, v72
    v_add_f32 v6, v6, v8
    v_add_f32 v7, v7, v9
    v_lshlrev_b32 v8, 16, v73
    v_and_b32 v9, s22, v73
    v_add_f32 v6, v6, v8
    v_add_f32 v7, v7, v9
    v_lshlrev_b32 v8, 16, v74
    v_and_b32 v9, s22, v74
    v_add_f32 v6, v6, v8
    v_add_f32 v7, v7, v9
    v_lshlrev_b32 v8, 16, v75
    v_and_b32 v9, s22, v75
    v_add_f32 v6, v6, v8
    v_add_f32 v7, v7, v9
    v_lshlrev_b32 v8, 16, v76
    v_and_b32 v9, s22, v76
    v_add_f32 v6, v6, v8
    v_add_f32 v7, v7, v9
    v_lshlrev_b32 v8, 16, v77
    v_and_b32 v9, s22, v77
    v_add_f32 v6, v6, v8
    v_add_f32 v7, v7, v9
    v_lshlrev_b32 v8, 16, v78
    v_and_b32 v9, s22, v78
    v_add_f32 v6, v6, v8
    v_add_f32 v7, v7, v9
    v_lshlrev_b32 v8, 16, v79
    v_and_b32 v9, s22, v79
    v_add_f32 v6, v6, v8
    v_add_f32 v7, v7, v9
    v_lshlrev_b32 v8, 16, v80
    v_and_b32 v9, s22, v80
    v_add_f32 v6, v6, v8
    v_add_f32 v7, v7, v9
    v_lshlrev_b32 v8, 16, v81
    v_and_b32 v9, s22, v81
    v_add_f32 v6, v6, v8
    v_add_f32 v7, v7, v9
    v_lshlrev_b32 v8, 16, v82
    v_and_b32 v9, s22, v82
    v_add_f32 v6, v6, v8
    v_add_f32 v7, v7, v9
    v_lshlrev_b32 v8, 16, v83
    v_and_b32 v9, s22, v83
    v_add_f32 v6, v6, v8
    v_add_f32 v7, v7, v9
    v_lshlrev_b32 v8, 16, v84
    v_and_b32 v9, s22, v84
    v_add_f32 v6, v6, v8
    v_add_f32 v7, v7, v9
    v_lshlrev_b32 v8, 16, v85
    v_and_b32 v9, s22, v85
    v_add_f32 v6, v6, v8
    v_add_f32 v7, v7, v9
    v_lshlrev_b32 v8, 16, v86
    v_and_b32 v9, s22, v86
    v_add_f32 v6, v6, v8
    v_add_f32 v7, v7, v9
    v_lshlrev_b32 v8, 16, v87
    v_and_b32 v9, s22, v87
    v_add_f32 v6, v6, v8
    v_add_f32 v7, v7, v9
    v_lshlrev_b32 v8, 16, v88
    v_and_b32 v9, s22, v88
    v_add_f32 v6, v6, v8
    v_add_f32 v7, v7, v9
    v_lshlrev_b32 v8, 16, v89
    v_and_b32 v9, s22, v89
    v_add_f32 v6, v6, v8
    v_add_f32 v7, v7, v9
    v_lshlrev_b32 v8, 16, v90
    v_and_b32 v9, s22, v90
    v_add_f32 v6, v6, v8
    v_add_f32 v7, v7, v9
    v_lshlrev_b32 v8, 16, v91
    v_and_b32 v9, s22, v91
    v_add_f32 v6, v6, v8
    v_add_f32 v7, v7, v9
    v_lshlrev_b32 v8, 16, v92
    v_and_b32 v9, s22, v92
    v_add_f32 v6, v6, v8
    v_add_f32 v7, v7, v9
    v_lshlrev_b32 v8, 16, v93
    v_and_b32 v9, s22, v93
    v_add_f32 v6, v6, v8
    v_add_f32 v7, v7, v9
    v_lshlrev_b32 v8, 16, v94
    v_and_b32 v9, s22, v94
    v_add_f32 v6, v6, v8
    v_add_f32 v7, v7, v9
    v_lshlrev_b32 v8, 16, v95
    v_and_b32 v9, s22, v95
    v_add_f32 v6, v6, v8
    v_add_f32 v7, v7, v9
    v_add_f32 v6, v6, v7
    v_mov_b32 v8, v6
    s_nop 1
    v_permlane32_swap_b32 v8, v6
    v_add_f32 v6, v6, v8
    v_mov_b32 v8, v6
    s_nop 1
    v_permlane16_swap_b32 v8, v6
    v_add_f32 v6, v6, v8
    v_mul_f32 v6, 0x3acccccd, v6
    v_mov_b32 v7, 0
    v_mov_b32 v10, 0
    v_lshlrev_b32 v8, 16, v16
    v_and_b32 v9, s22, v16
    v_sub_f32 v8, v8, v6
    v_sub_f32 v9, v9, v6
    v_fmac_f32 v7, v8, v8
    v_fmac_f32 v10, v9, v9
    v_lshlrev_b32 v8, 16, v17
    v_and_b32 v9, s22, v17
    v_sub_f32 v8, v8, v6
    v_sub_f32 v9, v9, v6
    v_fmac_f32 v7, v8, v8
    v_fmac_f32 v10, v9, v9
    v_lshlrev_b32 v8, 16, v18
    v_and_b32 v9, s22, v18
    v_sub_f32 v8, v8, v6
    v_sub_f32 v9, v9, v6
    v_fmac_f32 v7, v8, v8
    v_fmac_f32 v10, v9, v9
    v_lshlrev_b32 v8, 16, v19
    v_and_b32 v9, s22, v19
    v_sub_f32 v8, v8, v6
    v_sub_f32 v9, v9, v6
    v_fmac_f32 v7, v8, v8
    v_fmac_f32 v10, v9, v9
    v_lshlrev_b32 v8, 16, v20
    v_and_b32 v9, s22, v20
    v_sub_f32 v8, v8, v6
    v_sub_f32 v9, v9, v6
    v_fmac_f32 v7, v8, v8
    v_fmac_f32 v10, v9, v9
    v_lshlrev_b32 v8, 16, v21
    v_and_b32 v9, s22, v21
    v_sub_f32 v8, v8, v6
    v_sub_f32 v9, v9, v6
    v_fmac_f32 v7, v8, v8
    v_fmac_f32 v10, v9, v9
    v_lshlrev_b32 v8, 16, v22
    v_and_b32 v9, s22, v22
    v_sub_f32 v8, v8, v6
    v_sub_f32 v9, v9, v6
    v_fmac_f32 v7, v8, v8
    v_fmac_f32 v10, v9, v9
    v_lshlrev_b32 v8, 16, v23
    v_and_b32 v9, s22, v23
    v_sub_f32 v8, v8, v6
    v_sub_f32 v9, v9, v6
    v_fmac_f32 v7, v8, v8
    v_fmac_f32 v10, v9, v9
    v_lshlrev_b32 v8, 16, v24
    v_and_b32 v9, s22, v24
    v_sub_f32 v8, v8, v6
    v_sub_f32 v9, v9, v6
    v_fmac_f32 v7, v8, v8
    v_fmac_f32 v10, v9, v9
    v_lshlrev_b32 v8, 16, v25
    v_and_b32 v9, s22, v25
    v_sub_f32 v8, v8, v6
    v_sub_f32 v9, v9, v6
    v_fmac_f32 v7, v8, v8
    v_fmac_f32 v10, v9, v9
    v_lshlrev_b32 v8, 16, v26
    v_and_b32 v9, s22, v26
    v_sub_f32 v8, v8, v6
    v_sub_f32 v9, v9, v6
    v_fmac_f32 v7, v8, v8
    v_fmac_f32 v10, v9, v9
    v_lshlrev_b32 v8, 16, v27
    v_and_b32 v9, s22, v27
    v_sub_f32 v8, v8, v6
    v_sub_f32 v9, v9, v6
    v_fmac_f32 v7, v8, v8
    v_fmac_f32 v10, v9, v9
    v_lshlrev_b32 v8, 16, v28
    v_and_b32 v9, s22, v28
    v_sub_f32 v8, v8, v6
    v_sub_f32 v9, v9, v6
    v_fmac_f32 v7, v8, v8
    v_fmac_f32 v10, v9, v9
    v_lshlrev_b32 v8, 16, v29
    v_and_b32 v9, s22, v29
    v_sub_f32 v8, v8, v6
    v_sub_f32 v9, v9, v6
    v_fmac_f32 v7, v8, v8
    v_fmac_f32 v10, v9, v9
    v_lshlrev_b32 v8, 16, v30
    v_and_b32 v9, s22, v30
    v_sub_f32 v8, v8, v6
    v_sub_f32 v9, v9, v6
    v_fmac_f32 v7, v8, v8
    v_fmac_f32 v10, v9, v9
    v_lshlrev_b32 v8, 16, v31
    v_and_b32 v9, s22, v31
    v_sub_f32 v8, v8, v6
    v_sub_f32 v9, v9, v6
    v_fmac_f32 v7, v8, v8
    v_fmac_f32 v10, v9, v9
    v_lshlrev_b32 v8, 16, v32
    v_and_b32 v9, s22, v32
    v_sub_f32 v8, v8, v6
    v_sub_f32 v9, v9, v6
    v_fmac_f32 v7, v8, v8
    v_fmac_f32 v10, v9, v9
    v_lshlrev_b32 v8, 16, v33
    v_and_b32 v9, s22, v33
    v_sub_f32 v8, v8, v6
    v_sub_f32 v9, v9, v6
    v_fmac_f32 v7, v8, v8
    v_fmac_f32 v10, v9, v9
    v_lshlrev_b32 v8, 16, v34
    v_and_b32 v9, s22, v34
    v_sub_f32 v8, v8, v6
    v_sub_f32 v9, v9, v6
    v_fmac_f32 v7, v8, v8
    v_fmac_f32 v10, v9, v9
    v_lshlrev_b32 v8, 16, v35
    v_and_b32 v9, s22, v35
    v_sub_f32 v8, v8, v6
    v_sub_f32 v9, v9, v6
    v_fmac_f32 v7, v8, v8
    v_fmac_f32 v10, v9, v9
    v_lshlrev_b32 v8, 16, v36
    v_and_b32 v9, s22, v36
    v_sub_f32 v8, v8, v6
    v_sub_f32 v9, v9, v6
    v_fmac_f32 v7, v8, v8
    v_fmac_f32 v10, v9, v9
    v_lshlrev_b32 v8, 16, v37
    v_and_b32 v9, s22, v37
    v_sub_f32 v8, v8, v6
    v_sub_f32 v9, v9, v6
    v_fmac_f32 v7, v8, v8
    v_fmac_f32 v10, v9, v9
    v_lshlrev_b32 v8, 16, v38
    v_and_b32 v9, s22, v38
    v_sub_f32 v8, v8, v6
    v_sub_f32 v9, v9, v6
    v_fmac_f32 v7, v8, v8
    v_fmac_f32 v10, v9, v9
    v_lshlrev_b32 v8, 16, v39
    v_and_b32 v9, s22, v39
    v_sub_f32 v8, v8, v6
    v_sub_f32 v9, v9, v6
    v_fmac_f32 v7, v8, v8
    v_fmac_f32 v10, v9, v9
    v_lshlrev_b32 v8, 16, v40
    v_and_b32 v9, s22, v40
    v_sub_f32 v8, v8, v6
    v_sub_f32 v9, v9, v6
    v_fmac_f32 v7, v8, v8
    v_fmac_f32 v10, v9, v9
    v_lshlrev_b32 v8, 16, v41
    v_and_b32 v9, s22, v41
    v_sub_f32 v8, v8, v6
    v_sub_f32 v9, v9, v6
    v_fmac_f32 v7, v8, v8
    v_fmac_f32 v10, v9, v9
    v_lshlrev_b32 v8, 16, v42
    v_and_b32 v9, s22, v42
    v_sub_f32 v8, v8, v6
    v_sub_f32 v9, v9, v6
    v_fmac_f32 v7, v8, v8
    v_fmac_f32 v10, v9, v9
    v_lshlrev_b32 v8, 16, v43
    v_and_b32 v9, s22, v43
    v_sub_f32 v8, v8, v6
    v_sub_f32 v9, v9, v6
    v_fmac_f32 v7, v8, v8
    v_fmac_f32 v10, v9, v9
    v_lshlrev_b32 v8, 16, v44
    v_and_b32 v9, s22, v44
    v_sub_f32 v8, v8, v6
    v_sub_f32 v9, v9, v6
    v_fmac_f32 v7, v8, v8
    v_fmac_f32 v10, v9, v9
    v_lshlrev_b32 v8, 16, v45
    v_and_b32 v9, s22, v45
    v_sub_f32 v8, v8, v6
    v_sub_f32 v9, v9, v6
    v_fmac_f32 v7, v8, v8
    v_fmac_f32 v10, v9, v9
    v_lshlrev_b32 v8, 16, v46
    v_and_b32 v9, s22, v46
    v_sub_f32 v8, v8, v6
    v_sub_f32 v9, v9, v6
    v_fmac_f32 v7, v8, v8
    v_fmac_f32 v10, v9, v9
    v_lshlrev_b32 v8, 16, v47
    v_and_b32 v9, s22, v47
    v_sub_f32 v8, v8, v6
    v_sub_f32 v9, v9, v6
    v_fmac_f32 v7, v8, v8
    v_fmac_f32 v10, v9, v9
    v_lshlrev_b32 v8, 16, v48
    v_and_b32 v9, s22, v48
    v_sub_f32 v8, v8, v6
    v_sub_f32 v9, v9, v6
    v_fmac_f32 v7, v8, v8
    v_fmac_f32 v10, v9, v9
    v_lshlrev_b32 v8, 16, v49
    v_and_b32 v9, s22, v49
    v_sub_f32 v8, v8, v6
    v_sub_f32 v9, v9, v6
    v_fmac_f32 v7, v8, v8
    v_fmac_f32 v10, v9, v9
    v_lshlrev_b32 v8, 16, v50
    v_and_b32 v9, s22, v50
    v_sub_f32 v8, v8, v6
    v_sub_f32 v9, v9, v6
    v_fmac_f32 v7, v8, v8
    v_fmac_f32 v10, v9, v9
    v_lshlrev_b32 v8, 16, v51
    v_and_b32 v9, s22, v51
    v_sub_f32 v8, v8, v6
    v_sub_f32 v9, v9, v6
    v_fmac_f32 v7, v8, v8
    v_fmac_f32 v10, v9, v9
    v_lshlrev_b32 v8, 16, v52
    v_and_b32 v9, s22, v52
    v_sub_f32 v8, v8, v6
    v_sub_f32 v9, v9, v6
    v_fmac_f32 v7, v8, v8
    v_fmac_f32 v10, v9, v9
    v_lshlrev_b32 v8, 16, v53
    v_and_b32 v9, s22, v53
    v_sub_f32 v8, v8, v6
    v_sub_f32 v9, v9, v6
    v_fmac_f32 v7, v8, v8
    v_fmac_f32 v10, v9, v9
    v_lshlrev_b32 v8, 16, v54
    v_and_b32 v9, s22, v54
    v_sub_f32 v8, v8, v6
    v_sub_f32 v9, v9, v6
    v_fmac_f32 v7, v8, v8
    v_fmac_f32 v10, v9, v9
    v_lshlrev_b32 v8, 16, v55
    v_and_b32 v9, s22, v55
    v_sub_f32 v8, v8, v6
    v_sub_f32 v9, v9, v6
    v_fmac_f32 v7, v8, v8
    v_fmac_f32 v10, v9, v9
    v_lshlrev_b32 v8, 16, v56
    v_and_b32 v9, s22, v56
    v_sub_f32 v8, v8, v6
    v_sub_f32 v9, v9, v6
    v_fmac_f32 v7, v8, v8
    v_fmac_f32 v10, v9, v9
    v_lshlrev_b32 v8, 16, v57
    v_and_b32 v9, s22, v57
    v_sub_f32 v8, v8, v6
    v_sub_f32 v9, v9, v6
    v_fmac_f32 v7, v8, v8
    v_fmac_f32 v10, v9, v9
    v_lshlrev_b32 v8, 16, v58
    v_and_b32 v9, s22, v58
    v_sub_f32 v8, v8, v6
    v_sub_f32 v9, v9, v6
    v_fmac_f32 v7, v8, v8
    v_fmac_f32 v10, v9, v9
    v_lshlrev_b32 v8, 16, v59
    v_and_b32 v9, s22, v59
    v_sub_f32 v8, v8, v6
    v_sub_f32 v9, v9, v6
    v_fmac_f32 v7, v8, v8
    v_fmac_f32 v10, v9, v9
    v_lshlrev_b32 v8, 16, v60
    v_and_b32 v9, s22, v60
    v_sub_f32 v8, v8, v6
    v_sub_f32 v9, v9, v6
    v_fmac_f32 v7, v8, v8
    v_fmac_f32 v10, v9, v9
    v_lshlrev_b32 v8, 16, v61
    v_and_b32 v9, s22, v61
    v_sub_f32 v8, v8, v6
    v_sub_f32 v9, v9, v6
    v_fmac_f32 v7, v8, v8
    v_fmac_f32 v10, v9, v9
    v_lshlrev_b32 v8, 16, v62
    v_and_b32 v9, s22, v62
    v_sub_f32 v8, v8, v6
    v_sub_f32 v9, v9, v6
    v_fmac_f32 v7, v8, v8
    v_fmac_f32 v10, v9, v9
    v_lshlrev_b32 v8, 16, v63
    v_and_b32 v9, s22, v63
    v_sub_f32 v8, v8, v6
    v_sub_f32 v9, v9, v6
    v_fmac_f32 v7, v8, v8
    v_fmac_f32 v10, v9, v9
    v_lshlrev_b32 v8, 16, v64
    v_and_b32 v9, s22, v64
    v_sub_f32 v8, v8, v6
    v_sub_f32 v9, v9, v6
    v_fmac_f32 v7, v8, v8
    v_fmac_f32 v10, v9, v9
    v_lshlrev_b32 v8, 16, v65
    v_and_b32 v9, s22, v65
    v_sub_f32 v8, v8, v6
    v_sub_f32 v9, v9, v6
    v_fmac_f32 v7, v8, v8
    v_fmac_f32 v10, v9, v9
    v_lshlrev_b32 v8, 16, v66
    v_and_b32 v9, s22, v66
    v_sub_f32 v8, v8, v6
    v_sub_f32 v9, v9, v6
    v_fmac_f32 v7, v8, v8
    v_fmac_f32 v10, v9, v9
    v_lshlrev_b32 v8, 16, v67
    v_and_b32 v9, s22, v67
    v_sub_f32 v8, v8, v6
    v_sub_f32 v9, v9, v6
    v_fmac_f32 v7, v8, v8
    v_fmac_f32 v10, v9, v9
    v_lshlrev_b32 v8, 16, v68
    v_and_b32 v9, s22, v68
    v_sub_f32 v8, v8, v6
    v_sub_f32 v9, v9, v6
    v_fmac_f32 v7, v8, v8
    v_fmac_f32 v10, v9, v9
    v_lshlrev_b32 v8, 16, v69
    v_and_b32 v9, s22, v69
    v_sub_f32 v8, v8, v6
    v_sub_f32 v9, v9, v6
    v_fmac_f32 v7, v8, v8
    v_fmac_f32 v10, v9, v9
    v_lshlrev_b32 v8, 16, v70
    v_and_b32 v9, s22, v70
    v_sub_f32 v8, v8, v6
    v_sub_f32 v9, v9, v6
    v_fmac_f32 v7, v8, v8
    v_fmac_f32 v10, v9, v9
    v_lshlrev_b32 v8, 16, v71
    v_and_b32 v9, s22, v71
    v_sub_f32 v8, v8, v6
    v_sub_f32 v9, v9, v6
    v_fmac_f32 v7, v8, v8
    v_fmac_f32 v10, v9, v9
    v_lshlrev_b32 v8, 16, v72
    v_and_b32 v9, s22, v72
    v_sub_f32 v8, v8, v6
    v_sub_f32 v9, v9, v6
    v_fmac_f32 v7, v8, v8
    v_fmac_f32 v10, v9, v9
    v_lshlrev_b32 v8, 16, v73
    v_and_b32 v9, s22, v73
    v_sub_f32 v8, v8, v6
    v_sub_f32 v9, v9, v6
    v_fmac_f32 v7, v8, v8
    v_fmac_f32 v10, v9, v9
    v_lshlrev_b32 v8, 16, v74
    v_and_b32 v9, s22, v74
    v_sub_f32 v8, v8, v6
    v_sub_f32 v9, v9, v6
    v_fmac_f32 v7, v8, v8
    v_fmac_f32 v10, v9, v9
    v_lshlrev_b32 v8, 16, v75
    v_and_b32 v9, s22, v75
    v_sub_f32 v8, v8, v6
    v_sub_f32 v9, v9, v6
    v_fmac_f32 v7, v8, v8
    v_fmac_f32 v10, v9, v9
    v_lshlrev_b32 v8, 16, v76
    v_and_b32 v9, s22, v76
    v_sub_f32 v8, v8, v6
    v_sub_f32 v9, v9, v6
    v_fmac_f32 v7, v8, v8
    v_fmac_f32 v10, v9, v9
    v_lshlrev_b32 v8, 16, v77
    v_and_b32 v9, s22, v77
    v_sub_f32 v8, v8, v6
    v_sub_f32 v9, v9, v6
    v_fmac_f32 v7, v8, v8
    v_fmac_f32 v10, v9, v9
    v_lshlrev_b32 v8, 16, v78
    v_and_b32 v9, s22, v78
    v_sub_f32 v8, v8, v6
    v_sub_f32 v9, v9, v6
    v_fmac_f32 v7, v8, v8
    v_fmac_f32 v10, v9, v9
    v_lshlrev_b32 v8, 16, v79
    v_and_b32 v9, s22, v79
    v_sub_f32 v8, v8, v6
    v_sub_f32 v9, v9, v6
    v_fmac_f32 v7, v8, v8
    v_fmac_f32 v10, v9, v9
    v_lshlrev_b32 v8, 16, v80
    v_and_b32 v9, s22, v80
    v_sub_f32 v8, v8, v6
    v_sub_f32 v9, v9, v6
    v_fmac_f32 v7, v8, v8
    v_fmac_f32 v10, v9, v9
    v_lshlrev_b32 v8, 16, v81
    v_and_b32 v9, s22, v81
    v_sub_f32 v8, v8, v6
    v_sub_f32 v9, v9, v6
    v_fmac_f32 v7, v8, v8
    v_fmac_f32 v10, v9, v9
    v_lshlrev_b32 v8, 16, v82
    v_and_b32 v9, s22, v82
    v_sub_f32 v8, v8, v6
    v_sub_f32 v9, v9, v6
    v_fmac_f32 v7, v8, v8
    v_fmac_f32 v10, v9, v9
    v_lshlrev_b32 v8, 16, v83
    v_and_b32 v9, s22, v83
    v_sub_f32 v8, v8, v6
    v_sub_f32 v9, v9, v6
    v_fmac_f32 v7, v8, v8
    v_fmac_f32 v10, v9, v9
    v_lshlrev_b32 v8, 16, v84
    v_and_b32 v9, s22, v84
    v_sub_f32 v8, v8, v6
    v_sub_f32 v9, v9, v6
    v_fmac_f32 v7, v8, v8
    v_fmac_f32 v10, v9, v9
    v_lshlrev_b32 v8, 16, v85
    v_and_b32 v9, s22, v85
    v_sub_f32 v8, v8, v6
    v_sub_f32 v9, v9, v6
    v_fmac_f32 v7, v8, v8
    v_fmac_f32 v10, v9, v9
    v_lshlrev_b32 v8, 16, v86
    v_and_b32 v9, s22, v86
    v_sub_f32 v8, v8, v6
    v_sub_f32 v9, v9, v6
    v_fmac_f32 v7, v8, v8
    v_fmac_f32 v10, v9, v9
    v_lshlrev_b32 v8, 16, v87
    v_and_b32 v9, s22, v87
    v_sub_f32 v8, v8, v6
    v_sub_f32 v9, v9, v6
    v_fmac_f32 v7, v8, v8
    v_fmac_f32 v10, v9, v9
    v_lshlrev_b32 v8, 16, v88
    v_and_b32 v9, s22, v88
    v_sub_f32 v8, v8, v6
    v_sub_f32 v9, v9, v6
    v_fmac_f32 v7, v8, v8
    v_fmac_f32 v10, v9, v9
    v_lshlrev_b32 v8, 16, v89
    v_and_b32 v9, s22, v89
    v_sub_f32 v8, v8, v6
    v_sub_f32 v9, v9, v6
    v_fmac_f32 v7, v8, v8
    v_fmac_f32 v10, v9, v9
    v_lshlrev_b32 v8, 16, v90
    v_and_b32 v9, s22, v90
    v_sub_f32 v8, v8, v6
    v_sub_f32 v9, v9, v6
    v_fmac_f32 v7, v8, v8
    v_fmac_f32 v10, v9, v9
    v_lshlrev_b32 v8, 16, v91
    v_and_b32 v9, s22, v91
    v_sub_f32 v8, v8, v6
    v_sub_f32 v9, v9, v6
    v_fmac_f32 v7, v8, v8
    v_fmac_f32 v10, v9, v9
    v_lshlrev_b32 v8, 16, v92
    v_and_b32 v9, s22, v92
    v_sub_f32 v8, v8, v6
    v_sub_f32 v9, v9, v6
    v_fmac_f32 v7, v8, v8
    v_fmac_f32 v10, v9, v9
    v_lshlrev_b32 v8, 16, v93
    v_and_b32 v9, s22, v93
    v_sub_f32 v8, v8, v6
    v_sub_f32 v9, v9, v6
    v_fmac_f32 v7, v8, v8
    v_fmac_f32 v10, v9, v9
    v_lshlrev_b32 v8, 16, v94
    v_and_b32 v9, s22, v94
    v_sub_f32 v8, v8, v6
    v_sub_f32 v9, v9, v6
    v_fmac_f32 v7, v8, v8
    v_fmac_f32 v10, v9, v9
    v_lshlrev_b32 v8, 16, v95
    v_and_b32 v9, s22, v95
    v_sub_f32 v8, v8, v6
    v_sub_f32 v9, v9, v6
    v_fmac_f32 v7, v8, v8
    v_fmac_f32 v10, v9, v9
    v_add_f32 v7, v7, v10
    v_mov_b32 v8, v7
    s_nop 1
    v_permlane32_swap_b32 v8, v7
    v_add_f32 v7, v7, v8
    v_mov_b32 v8, v7
    s_nop 1
    v_permlane16_swap_b32 v8, v7
    v_add_f32 v7, v7, v8
    v_mul_f32 v7, 0x3acccccd, v7
    v_cvt_pk_bf16_f32 v7, v7, v7
    v_and_b32 v7, s22, v7
    v_add_f32 v7, 0x3727c5ac, v7
    v_cvt_pk_bf16_f32 v7, v7, v7
    v_and_b32 v7, s22, v7
    v_sqrt_f32 v7, v7
    s_nop 0
    v_cvt_pk_bf16_f32 v7, v7, v7
    v_and_b32 v7, s22, v7
    v_rcp_f32 v7, v7
    v_cvt_pk_bf16_f32 v6, v6, v6
    v_and_b32 v6, s22, v6
    s_add_u32 s21, s21, 35651584
    v_lshlrev_b32 v8, 16, v16
    v_and_b32 v9, s22, v16
    v_sub_f32 v8, v8, v6
    v_sub_f32 v9, v9, v6
    v_cvt_pk_bf16_f32 v9, v8, v9
    v_lshlrev_b32 v8, 16, v9
    v_and_b32 v9, s22, v9
    v_mul_f32 v8, v8, v7
    v_mul_f32 v9, v9, v7
    v_cvt_pk_bf16_f32 v96, v8, v9
    v_lshlrev_b32 v8, 16, v18
    v_and_b32 v9, s22, v18
    v_sub_f32 v8, v8, v6
    v_sub_f32 v9, v9, v6
    v_cvt_pk_bf16_f32 v9, v8, v9
    v_lshlrev_b32 v8, 16, v9
    v_and_b32 v9, s22, v9
    v_mul_f32 v8, v8, v7
    v_mul_f32 v9, v9, v7
    v_cvt_pk_bf16_f32 v97, v8, v9
    v_lshlrev_b32 v8, 16, v17
    v_and_b32 v9, s22, v17
    v_sub_f32 v8, v8, v6
    v_sub_f32 v9, v9, v6
    v_cvt_pk_bf16_f32 v9, v8, v9
    v_lshlrev_b32 v8, 16, v9
    v_and_b32 v9, s22, v9
    v_mul_f32 v8, v8, v7
    v_mul_f32 v9, v9, v7
    v_cvt_pk_bf16_f32 v98, v8, v9
    v_lshlrev_b32 v8, 16, v19
    v_and_b32 v9, s22, v19
    v_sub_f32 v8, v8, v6
    v_sub_f32 v9, v9, v6
    v_cvt_pk_bf16_f32 v9, v8, v9
    v_lshlrev_b32 v8, 16, v9
    v_and_b32 v9, s22, v9
    v_mul_f32 v8, v8, v7
    v_mul_f32 v9, v9, v7
    v_cvt_pk_bf16_f32 v99, v8, v9
    buffer_store_dwordx4 v[96:99], v5, s[4:7], s21 offen
    s_add_u32 s21, s21, 1024
    v_lshlrev_b32 v8, 16, v20
    v_and_b32 v9, s22, v20
    v_sub_f32 v8, v8, v6
    v_sub_f32 v9, v9, v6
    v_cvt_pk_bf16_f32 v9, v8, v9
    v_lshlrev_b32 v8, 16, v9
    v_and_b32 v9, s22, v9
    v_mul_f32 v8, v8, v7
    v_mul_f32 v9, v9, v7
    v_cvt_pk_bf16_f32 v100, v8, v9
    v_lshlrev_b32 v8, 16, v22
    v_and_b32 v9, s22, v22
    v_sub_f32 v8, v8, v6
    v_sub_f32 v9, v9, v6
    v_cvt_pk_bf16_f32 v9, v8, v9
    v_lshlrev_b32 v8, 16, v9
    v_and_b32 v9, s22, v9
    v_mul_f32 v8, v8, v7
    v_mul_f32 v9, v9, v7
    v_cvt_pk_bf16_f32 v101, v8, v9
    v_lshlrev_b32 v8, 16, v21
    v_and_b32 v9, s22, v21
    v_sub_f32 v8, v8, v6
    v_sub_f32 v9, v9, v6
    v_cvt_pk_bf16_f32 v9, v8, v9
    v_lshlrev_b32 v8, 16, v9
    v_and_b32 v9, s22, v9
    v_mul_f32 v8, v8, v7
    v_mul_f32 v9, v9, v7
    v_cvt_pk_bf16_f32 v102, v8, v9
    v_lshlrev_b32 v8, 16, v23
    v_and_b32 v9, s22, v23
    v_sub_f32 v8, v8, v6
    v_sub_f32 v9, v9, v6
    v_cvt_pk_bf16_f32 v9, v8, v9
    v_lshlrev_b32 v8, 16, v9
    v_and_b32 v9, s22, v9
    v_mul_f32 v8, v8, v7
    v_mul_f32 v9, v9, v7
    v_cvt_pk_bf16_f32 v103, v8, v9
    buffer_store_dwordx4 v[100:103], v5, s[4:7], s21 offen
    s_add_u32 s21, s21, 1024
    v_lshlrev_b32 v8, 16, v24
    v_and_b32 v9, s22, v24
    v_sub_f32 v8, v8, v6
    v_sub_f32 v9, v9, v6
    v_cvt_pk_bf16_f32 v9, v8, v9
    v_lshlrev_b32 v8, 16, v9
    v_and_b32 v9, s22, v9
    v_mul_f32 v8, v8, v7
    v_mul_f32 v9, v9, v7
    v_cvt_pk_bf16_f32 v96, v8, v9
    v_lshlrev_b32 v8, 16, v26
    v_and_b32 v9, s22, v26
    v_sub_f32 v8, v8, v6
    v_sub_f32 v9, v9, v6
    v_cvt_pk_bf16_f32 v9, v8, v9
    v_lshlrev_b32 v8, 16, v9
    v_and_b32 v9, s22, v9
    v_mul_f32 v8, v8, v7
    v_mul_f32 v9, v9, v7
    v_cvt_pk_bf16_f32 v97, v8, v9
    v_lshlrev_b32 v8, 16, v25
    v_and_b32 v9, s22, v25
    v_sub_f32 v8, v8, v6
    v_sub_f32 v9, v9, v6
    v_cvt_pk_bf16_f32 v9, v8, v9
    v_lshlrev_b32 v8, 16, v9
    v_and_b32 v9, s22, v9
    v_mul_f32 v8, v8, v7
    v_mul_f32 v9, v9, v7
    v_cvt_pk_bf16_f32 v98, v8, v9
    v_lshlrev_b32 v8, 16, v27
    v_and_b32 v9, s22, v27
    v_sub_f32 v8, v8, v6
    v_sub_f32 v9, v9, v6
    v_cvt_pk_bf16_f32 v9, v8, v9
    v_lshlrev_b32 v8, 16, v9
    v_and_b32 v9, s22, v9
    v_mul_f32 v8, v8, v7
    v_mul_f32 v9, v9, v7
    v_cvt_pk_bf16_f32 v99, v8, v9
    buffer_store_dwordx4 v[96:99], v5, s[4:7], s21 offen
    s_add_u32 s21, s21, 1024
    v_lshlrev_b32 v8, 16, v28
    v_and_b32 v9, s22, v28
    v_sub_f32 v8, v8, v6
    v_sub_f32 v9, v9, v6
    v_cvt_pk_bf16_f32 v9, v8, v9
    v_lshlrev_b32 v8, 16, v9
    v_and_b32 v9, s22, v9
    v_mul_f32 v8, v8, v7
    v_mul_f32 v9, v9, v7
    v_cvt_pk_bf16_f32 v100, v8, v9
    v_lshlrev_b32 v8, 16, v30
    v_and_b32 v9, s22, v30
    v_sub_f32 v8, v8, v6
    v_sub_f32 v9, v9, v6
    v_cvt_pk_bf16_f32 v9, v8, v9
    v_lshlrev_b32 v8, 16, v9
    v_and_b32 v9, s22, v9
    v_mul_f32 v8, v8, v7
    v_mul_f32 v9, v9, v7
    v_cvt_pk_bf16_f32 v101, v8, v9
    v_lshlrev_b32 v8, 16, v29
    v_and_b32 v9, s22, v29
    v_sub_f32 v8, v8, v6
    v_sub_f32 v9, v9, v6
    v_cvt_pk_bf16_f32 v9, v8, v9
    v_lshlrev_b32 v8, 16, v9
    v_and_b32 v9, s22, v9
    v_mul_f32 v8, v8, v7
    v_mul_f32 v9, v9, v7
    v_cvt_pk_bf16_f32 v102, v8, v9
    v_lshlrev_b32 v8, 16, v31
    v_and_b32 v9, s22, v31
    v_sub_f32 v8, v8, v6
    v_sub_f32 v9, v9, v6
    v_cvt_pk_bf16_f32 v9, v8, v9
    v_lshlrev_b32 v8, 16, v9
    v_and_b32 v9, s22, v9
    v_mul_f32 v8, v8, v7
    v_mul_f32 v9, v9, v7
    v_cvt_pk_bf16_f32 v103, v8, v9
    buffer_store_dwordx4 v[100:103], v5, s[4:7], s21 offen
    s_add_u32 s21, s21, 1024
    v_lshlrev_b32 v8, 16, v32
    v_and_b32 v9, s22, v32
    v_sub_f32 v8, v8, v6
    v_sub_f32 v9, v9, v6
    v_cvt_pk_bf16_f32 v9, v8, v9
    v_lshlrev_b32 v8, 16, v9
    v_and_b32 v9, s22, v9
    v_mul_f32 v8, v8, v7
    v_mul_f32 v9, v9, v7
    v_cvt_pk_bf16_f32 v96, v8, v9
    v_lshlrev_b32 v8, 16, v34
    v_and_b32 v9, s22, v34
    v_sub_f32 v8, v8, v6
    v_sub_f32 v9, v9, v6
    v_cvt_pk_bf16_f32 v9, v8, v9
    v_lshlrev_b32 v8, 16, v9
    v_and_b32 v9, s22, v9
    v_mul_f32 v8, v8, v7
    v_mul_f32 v9, v9, v7
    v_cvt_pk_bf16_f32 v97, v8, v9
    v_lshlrev_b32 v8, 16, v33
    v_and_b32 v9, s22, v33
    v_sub_f32 v8, v8, v6
    v_sub_f32 v9, v9, v6
    v_cvt_pk_bf16_f32 v9, v8, v9
    v_lshlrev_b32 v8, 16, v9
    v_and_b32 v9, s22, v9
    v_mul_f32 v8, v8, v7
    v_mul_f32 v9, v9, v7
    v_cvt_pk_bf16_f32 v98, v8, v9
    v_lshlrev_b32 v8, 16, v35
    v_and_b32 v9, s22, v35
    v_sub_f32 v8, v8, v6
    v_sub_f32 v9, v9, v6
    v_cvt_pk_bf16_f32 v9, v8, v9
    v_lshlrev_b32 v8, 16, v9
    v_and_b32 v9, s22, v9
    v_mul_f32 v8, v8, v7
    v_mul_f32 v9, v9, v7
    v_cvt_pk_bf16_f32 v99, v8, v9
    buffer_store_dwordx4 v[96:99], v5, s[4:7], s21 offen
    s_add_u32 s21, s21, 1024
    v_lshlrev_b32 v8, 16, v36
    v_and_b32 v9, s22, v36
    v_sub_f32 v8, v8, v6
    v_sub_f32 v9, v9, v6
    v_cvt_pk_bf16_f32 v9, v8, v9
    v_lshlrev_b32 v8, 16, v9
    v_and_b32 v9, s22, v9
    v_mul_f32 v8, v8, v7
    v_mul_f32 v9, v9, v7
    v_cvt_pk_bf16_f32 v100, v8, v9
    v_lshlrev_b32 v8, 16, v38
    v_and_b32 v9, s22, v38
    v_sub_f32 v8, v8, v6
    v_sub_f32 v9, v9, v6
    v_cvt_pk_bf16_f32 v9, v8, v9
    v_lshlrev_b32 v8, 16, v9
    v_and_b32 v9, s22, v9
    v_mul_f32 v8, v8, v7
    v_mul_f32 v9, v9, v7
    v_cvt_pk_bf16_f32 v101, v8, v9
    v_lshlrev_b32 v8, 16, v37
    v_and_b32 v9, s22, v37
    v_sub_f32 v8, v8, v6
    v_sub_f32 v9, v9, v6
    v_cvt_pk_bf16_f32 v9, v8, v9
    v_lshlrev_b32 v8, 16, v9
    v_and_b32 v9, s22, v9
    v_mul_f32 v8, v8, v7
    v_mul_f32 v9, v9, v7
    v_cvt_pk_bf16_f32 v102, v8, v9
    v_lshlrev_b32 v8, 16, v39
    v_and_b32 v9, s22, v39
    v_sub_f32 v8, v8, v6
    v_sub_f32 v9, v9, v6
    v_cvt_pk_bf16_f32 v9, v8, v9
    v_lshlrev_b32 v8, 16, v9
    v_and_b32 v9, s22, v9
    v_mul_f32 v8, v8, v7
    v_mul_f32 v9, v9, v7
    v_cvt_pk_bf16_f32 v103, v8, v9
    buffer_store_dwordx4 v[100:103], v5, s[4:7], s21 offen
    s_add_u32 s21, s21, 1024
    v_lshlrev_b32 v8, 16, v40
    v_and_b32 v9, s22, v40
    v_sub_f32 v8, v8, v6
    v_sub_f32 v9, v9, v6
    v_cvt_pk_bf16_f32 v9, v8, v9
    v_lshlrev_b32 v8, 16, v9
    v_and_b32 v9, s22, v9
    v_mul_f32 v8, v8, v7
    v_mul_f32 v9, v9, v7
    v_cvt_pk_bf16_f32 v96, v8, v9
    v_lshlrev_b32 v8, 16, v42
    v_and_b32 v9, s22, v42
    v_sub_f32 v8, v8, v6
    v_sub_f32 v9, v9, v6
    v_cvt_pk_bf16_f32 v9, v8, v9
    v_lshlrev_b32 v8, 16, v9
    v_and_b32 v9, s22, v9
    v_mul_f32 v8, v8, v7
    v_mul_f32 v9, v9, v7
    v_cvt_pk_bf16_f32 v97, v8, v9
    v_lshlrev_b32 v8, 16, v41
    v_and_b32 v9, s22, v41
    v_sub_f32 v8, v8, v6
    v_sub_f32 v9, v9, v6
    v_cvt_pk_bf16_f32 v9, v8, v9
    v_lshlrev_b32 v8, 16, v9
    v_and_b32 v9, s22, v9
    v_mul_f32 v8, v8, v7
    v_mul_f32 v9, v9, v7
    v_cvt_pk_bf16_f32 v98, v8, v9
    v_lshlrev_b32 v8, 16, v43
    v_and_b32 v9, s22, v43
    v_sub_f32 v8, v8, v6
    v_sub_f32 v9, v9, v6
    v_cvt_pk_bf16_f32 v9, v8, v9
    v_lshlrev_b32 v8, 16, v9
    v_and_b32 v9, s22, v9
    v_mul_f32 v8, v8, v7
    v_mul_f32 v9, v9, v7
    v_cvt_pk_bf16_f32 v99, v8, v9
    buffer_store_dwordx4 v[96:99], v5, s[4:7], s21 offen
    s_add_u32 s21, s21, 1024
    v_lshlrev_b32 v8, 16, v44
    v_and_b32 v9, s22, v44
    v_sub_f32 v8, v8, v6
    v_sub_f32 v9, v9, v6
    v_cvt_pk_bf16_f32 v9, v8, v9
    v_lshlrev_b32 v8, 16, v9
    v_and_b32 v9, s22, v9
    v_mul_f32 v8, v8, v7
    v_mul_f32 v9, v9, v7
    v_cvt_pk_bf16_f32 v100, v8, v9
    v_lshlrev_b32 v8, 16, v46
    v_and_b32 v9, s22, v46
    v_sub_f32 v8, v8, v6
    v_sub_f32 v9, v9, v6
    v_cvt_pk_bf16_f32 v9, v8, v9
    v_lshlrev_b32 v8, 16, v9
    v_and_b32 v9, s22, v9
    v_mul_f32 v8, v8, v7
    v_mul_f32 v9, v9, v7
    v_cvt_pk_bf16_f32 v101, v8, v9
    v_lshlrev_b32 v8, 16, v45
    v_and_b32 v9, s22, v45
    v_sub_f32 v8, v8, v6
    v_sub_f32 v9, v9, v6
    v_cvt_pk_bf16_f32 v9, v8, v9
    v_lshlrev_b32 v8, 16, v9
    v_and_b32 v9, s22, v9
    v_mul_f32 v8, v8, v7
    v_mul_f32 v9, v9, v7
    v_cvt_pk_bf16_f32 v102, v8, v9
    v_lshlrev_b32 v8, 16, v47
    v_and_b32 v9, s22, v47
    v_sub_f32 v8, v8, v6
    v_sub_f32 v9, v9, v6
    v_cvt_pk_bf16_f32 v9, v8, v9
    v_lshlrev_b32 v8, 16, v9
    v_and_b32 v9, s22, v9
    v_mul_f32 v8, v8, v7
    v_mul_f32 v9, v9, v7
    v_cvt_pk_bf16_f32 v103, v8, v9
    buffer_store_dwordx4 v[100:103], v5, s[4:7], s21 offen
    s_add_u32 s21, s21, 1024
    v_lshlrev_b32 v8, 16, v48
    v_and_b32 v9, s22, v48
    v_sub_f32 v8, v8, v6
    v_sub_f32 v9, v9, v6
    v_cvt_pk_bf16_f32 v9, v8, v9
    v_lshlrev_b32 v8, 16, v9
    v_and_b32 v9, s22, v9
    v_mul_f32 v8, v8, v7
    v_mul_f32 v9, v9, v7
    v_cvt_pk_bf16_f32 v96, v8, v9
    v_lshlrev_b32 v8, 16, v50
    v_and_b32 v9, s22, v50
    v_sub_f32 v8, v8, v6
    v_sub_f32 v9, v9, v6
    v_cvt_pk_bf16_f32 v9, v8, v9
    v_lshlrev_b32 v8, 16, v9
    v_and_b32 v9, s22, v9
    v_mul_f32 v8, v8, v7
    v_mul_f32 v9, v9, v7
    v_cvt_pk_bf16_f32 v97, v8, v9
    v_lshlrev_b32 v8, 16, v49
    v_and_b32 v9, s22, v49
    v_sub_f32 v8, v8, v6
    v_sub_f32 v9, v9, v6
    v_cvt_pk_bf16_f32 v9, v8, v9
    v_lshlrev_b32 v8, 16, v9
    v_and_b32 v9, s22, v9
    v_mul_f32 v8, v8, v7
    v_mul_f32 v9, v9, v7
    v_cvt_pk_bf16_f32 v98, v8, v9
    v_lshlrev_b32 v8, 16, v51
    v_and_b32 v9, s22, v51
    v_sub_f32 v8, v8, v6
    v_sub_f32 v9, v9, v6
    v_cvt_pk_bf16_f32 v9, v8, v9
    v_lshlrev_b32 v8, 16, v9
    v_and_b32 v9, s22, v9
    v_mul_f32 v8, v8, v7
    v_mul_f32 v9, v9, v7
    v_cvt_pk_bf16_f32 v99, v8, v9
    buffer_store_dwordx4 v[96:99], v5, s[4:7], s21 offen
    s_add_u32 s21, s21, 1024
    v_lshlrev_b32 v8, 16, v52
    v_and_b32 v9, s22, v52
    v_sub_f32 v8, v8, v6
    v_sub_f32 v9, v9, v6
    v_cvt_pk_bf16_f32 v9, v8, v9
    v_lshlrev_b32 v8, 16, v9
    v_and_b32 v9, s22, v9
    v_mul_f32 v8, v8, v7
    v_mul_f32 v9, v9, v7
    v_cvt_pk_bf16_f32 v100, v8, v9
    v_lshlrev_b32 v8, 16, v54
    v_and_b32 v9, s22, v54
    v_sub_f32 v8, v8, v6
    v_sub_f32 v9, v9, v6
    v_cvt_pk_bf16_f32 v9, v8, v9
    v_lshlrev_b32 v8, 16, v9
    v_and_b32 v9, s22, v9
    v_mul_f32 v8, v8, v7
    v_mul_f32 v9, v9, v7
    v_cvt_pk_bf16_f32 v101, v8, v9
    v_lshlrev_b32 v8, 16, v53
    v_and_b32 v9, s22, v53
    v_sub_f32 v8, v8, v6
    v_sub_f32 v9, v9, v6
    v_cvt_pk_bf16_f32 v9, v8, v9
    v_lshlrev_b32 v8, 16, v9
    v_and_b32 v9, s22, v9
    v_mul_f32 v8, v8, v7
    v_mul_f32 v9, v9, v7
    v_cvt_pk_bf16_f32 v102, v8, v9
    v_lshlrev_b32 v8, 16, v55
    v_and_b32 v9, s22, v55
    v_sub_f32 v8, v8, v6
    v_sub_f32 v9, v9, v6
    v_cvt_pk_bf16_f32 v9, v8, v9
    v_lshlrev_b32 v8, 16, v9
    v_and_b32 v9, s22, v9
    v_mul_f32 v8, v8, v7
    v_mul_f32 v9, v9, v7
    v_cvt_pk_bf16_f32 v103, v8, v9
    buffer_store_dwordx4 v[100:103], v5, s[4:7], s21 offen
    s_add_u32 s21, s21, 1024
    v_lshlrev_b32 v8, 16, v56
    v_and_b32 v9, s22, v56
    v_sub_f32 v8, v8, v6
    v_sub_f32 v9, v9, v6
    v_cvt_pk_bf16_f32 v9, v8, v9
    v_lshlrev_b32 v8, 16, v9
    v_and_b32 v9, s22, v9
    v_mul_f32 v8, v8, v7
    v_mul_f32 v9, v9, v7
    v_cvt_pk_bf16_f32 v96, v8, v9
    v_lshlrev_b32 v8, 16, v58
    v_and_b32 v9, s22, v58
    v_sub_f32 v8, v8, v6
    v_sub_f32 v9, v9, v6
    v_cvt_pk_bf16_f32 v9, v8, v9
    v_lshlrev_b32 v8, 16, v9
    v_and_b32 v9, s22, v9
    v_mul_f32 v8, v8, v7
    v_mul_f32 v9, v9, v7
    v_cvt_pk_bf16_f32 v97, v8, v9
    v_lshlrev_b32 v8, 16, v57
    v_and_b32 v9, s22, v57
    v_sub_f32 v8, v8, v6
    v_sub_f32 v9, v9, v6
    v_cvt_pk_bf16_f32 v9, v8, v9
    v_lshlrev_b32 v8, 16, v9
    v_and_b32 v9, s22, v9
    v_mul_f32 v8, v8, v7
    v_mul_f32 v9, v9, v7
    v_cvt_pk_bf16_f32 v98, v8, v9
    v_lshlrev_b32 v8, 16, v59
    v_and_b32 v9, s22, v59
    v_sub_f32 v8, v8, v6
    v_sub_f32 v9, v9, v6
    v_cvt_pk_bf16_f32 v9, v8, v9
    v_lshlrev_b32 v8, 16, v9
    v_and_b32 v9, s22, v9
    v_mul_f32 v8, v8, v7
    v_mul_f32 v9, v9, v7
    v_cvt_pk_bf16_f32 v99, v8, v9
    buffer_store_dwordx4 v[96:99], v5, s[4:7], s21 offen
    s_add_u32 s21, s21, 1024
    v_lshlrev_b32 v8, 16, v60
    v_and_b32 v9, s22, v60
    v_sub_f32 v8, v8, v6
    v_sub_f32 v9, v9, v6
    v_cvt_pk_bf16_f32 v9, v8, v9
    v_lshlrev_b32 v8, 16, v9
    v_and_b32 v9, s22, v9
    v_mul_f32 v8, v8, v7
    v_mul_f32 v9, v9, v7
    v_cvt_pk_bf16_f32 v100, v8, v9
    v_lshlrev_b32 v8, 16, v62
    v_and_b32 v9, s22, v62
    v_sub_f32 v8, v8, v6
    v_sub_f32 v9, v9, v6
    v_cvt_pk_bf16_f32 v9, v8, v9
    v_lshlrev_b32 v8, 16, v9
    v_and_b32 v9, s22, v9
    v_mul_f32 v8, v8, v7
    v_mul_f32 v9, v9, v7
    v_cvt_pk_bf16_f32 v101, v8, v9
    v_lshlrev_b32 v8, 16, v61
    v_and_b32 v9, s22, v61
    v_sub_f32 v8, v8, v6
    v_sub_f32 v9, v9, v6
    v_cvt_pk_bf16_f32 v9, v8, v9
    v_lshlrev_b32 v8, 16, v9
    v_and_b32 v9, s22, v9
    v_mul_f32 v8, v8, v7
    v_mul_f32 v9, v9, v7
    v_cvt_pk_bf16_f32 v102, v8, v9
    v_lshlrev_b32 v8, 16, v63
    v_and_b32 v9, s22, v63
    v_sub_f32 v8, v8, v6
    v_sub_f32 v9, v9, v6
    v_cvt_pk_bf16_f32 v9, v8, v9
    v_lshlrev_b32 v8, 16, v9
    v_and_b32 v9, s22, v9
    v_mul_f32 v8, v8, v7
    v_mul_f32 v9, v9, v7
    v_cvt_pk_bf16_f32 v103, v8, v9
    buffer_store_dwordx4 v[100:103], v5, s[4:7], s21 offen
    s_add_u32 s21, s21, 1024
    v_lshlrev_b32 v8, 16, v64
    v_and_b32 v9, s22, v64
    v_sub_f32 v8, v8, v6
    v_sub_f32 v9, v9, v6
    v_cvt_pk_bf16_f32 v9, v8, v9
    v_lshlrev_b32 v8, 16, v9
    v_and_b32 v9, s22, v9
    v_mul_f32 v8, v8, v7
    v_mul_f32 v9, v9, v7
    v_cvt_pk_bf16_f32 v96, v8, v9
    v_lshlrev_b32 v8, 16, v66
    v_and_b32 v9, s22, v66
    v_sub_f32 v8, v8, v6
    v_sub_f32 v9, v9, v6
    v_cvt_pk_bf16_f32 v9, v8, v9
    v_lshlrev_b32 v8, 16, v9
    v_and_b32 v9, s22, v9
    v_mul_f32 v8, v8, v7
    v_mul_f32 v9, v9, v7
    v_cvt_pk_bf16_f32 v97, v8, v9
    v_lshlrev_b32 v8, 16, v65
    v_and_b32 v9, s22, v65
    v_sub_f32 v8, v8, v6
    v_sub_f32 v9, v9, v6
    v_cvt_pk_bf16_f32 v9, v8, v9
    v_lshlrev_b32 v8, 16, v9
    v_and_b32 v9, s22, v9
    v_mul_f32 v8, v8, v7
    v_mul_f32 v9, v9, v7
    v_cvt_pk_bf16_f32 v98, v8, v9
    v_lshlrev_b32 v8, 16, v67
    v_and_b32 v9, s22, v67
    v_sub_f32 v8, v8, v6
    v_sub_f32 v9, v9, v6
    v_cvt_pk_bf16_f32 v9, v8, v9
    v_lshlrev_b32 v8, 16, v9
    v_and_b32 v9, s22, v9
    v_mul_f32 v8, v8, v7
    v_mul_f32 v9, v9, v7
    v_cvt_pk_bf16_f32 v99, v8, v9
    buffer_store_dwordx4 v[96:99], v5, s[4:7], s21 offen
    s_add_u32 s21, s21, 1024
    v_lshlrev_b32 v8, 16, v68
    v_and_b32 v9, s22, v68
    v_sub_f32 v8, v8, v6
    v_sub_f32 v9, v9, v6
    v_cvt_pk_bf16_f32 v9, v8, v9
    v_lshlrev_b32 v8, 16, v9
    v_and_b32 v9, s22, v9
    v_mul_f32 v8, v8, v7
    v_mul_f32 v9, v9, v7
    v_cvt_pk_bf16_f32 v100, v8, v9
    v_lshlrev_b32 v8, 16, v70
    v_and_b32 v9, s22, v70
    v_sub_f32 v8, v8, v6
    v_sub_f32 v9, v9, v6
    v_cvt_pk_bf16_f32 v9, v8, v9
    v_lshlrev_b32 v8, 16, v9
    v_and_b32 v9, s22, v9
    v_mul_f32 v8, v8, v7
    v_mul_f32 v9, v9, v7
    v_cvt_pk_bf16_f32 v101, v8, v9
    v_lshlrev_b32 v8, 16, v69
    v_and_b32 v9, s22, v69
    v_sub_f32 v8, v8, v6
    v_sub_f32 v9, v9, v6
    v_cvt_pk_bf16_f32 v9, v8, v9
    v_lshlrev_b32 v8, 16, v9
    v_and_b32 v9, s22, v9
    v_mul_f32 v8, v8, v7
    v_mul_f32 v9, v9, v7
    v_cvt_pk_bf16_f32 v102, v8, v9
    v_lshlrev_b32 v8, 16, v71
    v_and_b32 v9, s22, v71
    v_sub_f32 v8, v8, v6
    v_sub_f32 v9, v9, v6
    v_cvt_pk_bf16_f32 v9, v8, v9
    v_lshlrev_b32 v8, 16, v9
    v_and_b32 v9, s22, v9
    v_mul_f32 v8, v8, v7
    v_mul_f32 v9, v9, v7
    v_cvt_pk_bf16_f32 v103, v8, v9
    buffer_store_dwordx4 v[100:103], v5, s[4:7], s21 offen
    s_add_u32 s21, s21, 1024
    v_lshlrev_b32 v8, 16, v72
    v_and_b32 v9, s22, v72
    v_sub_f32 v8, v8, v6
    v_sub_f32 v9, v9, v6
    v_cvt_pk_bf16_f32 v9, v8, v9
    v_lshlrev_b32 v8, 16, v9
    v_and_b32 v9, s22, v9
    v_mul_f32 v8, v8, v7
    v_mul_f32 v9, v9, v7
    v_cvt_pk_bf16_f32 v96, v8, v9
    v_lshlrev_b32 v8, 16, v74
    v_and_b32 v9, s22, v74
    v_sub_f32 v8, v8, v6
    v_sub_f32 v9, v9, v6
    v_cvt_pk_bf16_f32 v9, v8, v9
    v_lshlrev_b32 v8, 16, v9
    v_and_b32 v9, s22, v9
    v_mul_f32 v8, v8, v7
    v_mul_f32 v9, v9, v7
    v_cvt_pk_bf16_f32 v97, v8, v9
    v_lshlrev_b32 v8, 16, v73
    v_and_b32 v9, s22, v73
    v_sub_f32 v8, v8, v6
    v_sub_f32 v9, v9, v6
    v_cvt_pk_bf16_f32 v9, v8, v9
    v_lshlrev_b32 v8, 16, v9
    v_and_b32 v9, s22, v9
    v_mul_f32 v8, v8, v7
    v_mul_f32 v9, v9, v7
    v_cvt_pk_bf16_f32 v98, v8, v9
    v_lshlrev_b32 v8, 16, v75
    v_and_b32 v9, s22, v75
    v_sub_f32 v8, v8, v6
    v_sub_f32 v9, v9, v6
    v_cvt_pk_bf16_f32 v9, v8, v9
    v_lshlrev_b32 v8, 16, v9
    v_and_b32 v9, s22, v9
    v_mul_f32 v8, v8, v7
    v_mul_f32 v9, v9, v7
    v_cvt_pk_bf16_f32 v99, v8, v9
    buffer_store_dwordx4 v[96:99], v5, s[4:7], s21 offen
    s_add_u32 s21, s21, 1024
    v_lshlrev_b32 v8, 16, v76
    v_and_b32 v9, s22, v76
    v_sub_f32 v8, v8, v6
    v_sub_f32 v9, v9, v6
    v_cvt_pk_bf16_f32 v9, v8, v9
    v_lshlrev_b32 v8, 16, v9
    v_and_b32 v9, s22, v9
    v_mul_f32 v8, v8, v7
    v_mul_f32 v9, v9, v7
    v_cvt_pk_bf16_f32 v100, v8, v9
    v_lshlrev_b32 v8, 16, v78
    v_and_b32 v9, s22, v78
    v_sub_f32 v8, v8, v6
    v_sub_f32 v9, v9, v6
    v_cvt_pk_bf16_f32 v9, v8, v9
    v_lshlrev_b32 v8, 16, v9
    v_and_b32 v9, s22, v9
    v_mul_f32 v8, v8, v7
    v_mul_f32 v9, v9, v7
    v_cvt_pk_bf16_f32 v101, v8, v9
    v_lshlrev_b32 v8, 16, v77
    v_and_b32 v9, s22, v77
    v_sub_f32 v8, v8, v6
    v_sub_f32 v9, v9, v6
    v_cvt_pk_bf16_f32 v9, v8, v9
    v_lshlrev_b32 v8, 16, v9
    v_and_b32 v9, s22, v9
    v_mul_f32 v8, v8, v7
    v_mul_f32 v9, v9, v7
    v_cvt_pk_bf16_f32 v102, v8, v9
    v_lshlrev_b32 v8, 16, v79
    v_and_b32 v9, s22, v79
    v_sub_f32 v8, v8, v6
    v_sub_f32 v9, v9, v6
    v_cvt_pk_bf16_f32 v9, v8, v9
    v_lshlrev_b32 v8, 16, v9
    v_and_b32 v9, s22, v9
    v_mul_f32 v8, v8, v7
    v_mul_f32 v9, v9, v7
    v_cvt_pk_bf16_f32 v103, v8, v9
    buffer_store_dwordx4 v[100:103], v5, s[4:7], s21 offen
    s_add_u32 s21, s21, 1024
    v_lshlrev_b32 v8, 16, v80
    v_and_b32 v9, s22, v80
    v_sub_f32 v8, v8, v6
    v_sub_f32 v9, v9, v6
    v_cvt_pk_bf16_f32 v9, v8, v9
    v_lshlrev_b32 v8, 16, v9
    v_and_b32 v9, s22, v9
    v_mul_f32 v8, v8, v7
    v_mul_f32 v9, v9, v7
    v_cvt_pk_bf16_f32 v96, v8, v9
    v_lshlrev_b32 v8, 16, v82
    v_and_b32 v9, s22, v82
    v_sub_f32 v8, v8, v6
    v_sub_f32 v9, v9, v6
    v_cvt_pk_bf16_f32 v9, v8, v9
    v_lshlrev_b32 v8, 16, v9
    v_and_b32 v9, s22, v9
    v_mul_f32 v8, v8, v7
    v_mul_f32 v9, v9, v7
    v_cvt_pk_bf16_f32 v97, v8, v9
    v_lshlrev_b32 v8, 16, v81
    v_and_b32 v9, s22, v81
    v_sub_f32 v8, v8, v6
    v_sub_f32 v9, v9, v6
    v_cvt_pk_bf16_f32 v9, v8, v9
    v_lshlrev_b32 v8, 16, v9
    v_and_b32 v9, s22, v9
    v_mul_f32 v8, v8, v7
    v_mul_f32 v9, v9, v7
    v_cvt_pk_bf16_f32 v98, v8, v9
    v_lshlrev_b32 v8, 16, v83
    v_and_b32 v9, s22, v83
    v_sub_f32 v8, v8, v6
    v_sub_f32 v9, v9, v6
    v_cvt_pk_bf16_f32 v9, v8, v9
    v_lshlrev_b32 v8, 16, v9
    v_and_b32 v9, s22, v9
    v_mul_f32 v8, v8, v7
    v_mul_f32 v9, v9, v7
    v_cvt_pk_bf16_f32 v99, v8, v9
    buffer_store_dwordx4 v[96:99], v5, s[4:7], s21 offen
    s_add_u32 s21, s21, 1024
    v_lshlrev_b32 v8, 16, v84
    v_and_b32 v9, s22, v84
    v_sub_f32 v8, v8, v6
    v_sub_f32 v9, v9, v6
    v_cvt_pk_bf16_f32 v9, v8, v9
    v_lshlrev_b32 v8, 16, v9
    v_and_b32 v9, s22, v9
    v_mul_f32 v8, v8, v7
    v_mul_f32 v9, v9, v7
    v_cvt_pk_bf16_f32 v100, v8, v9
    v_lshlrev_b32 v8, 16, v86
    v_and_b32 v9, s22, v86
    v_sub_f32 v8, v8, v6
    v_sub_f32 v9, v9, v6
    v_cvt_pk_bf16_f32 v9, v8, v9
    v_lshlrev_b32 v8, 16, v9
    v_and_b32 v9, s22, v9
    v_mul_f32 v8, v8, v7
    v_mul_f32 v9, v9, v7
    v_cvt_pk_bf16_f32 v101, v8, v9
    v_lshlrev_b32 v8, 16, v85
    v_and_b32 v9, s22, v85
    v_sub_f32 v8, v8, v6
    v_sub_f32 v9, v9, v6
    v_cvt_pk_bf16_f32 v9, v8, v9
    v_lshlrev_b32 v8, 16, v9
    v_and_b32 v9, s22, v9
    v_mul_f32 v8, v8, v7
    v_mul_f32 v9, v9, v7
    v_cvt_pk_bf16_f32 v102, v8, v9
    v_lshlrev_b32 v8, 16, v87
    v_and_b32 v9, s22, v87
    v_sub_f32 v8, v8, v6
    v_sub_f32 v9, v9, v6
    v_cvt_pk_bf16_f32 v9, v8, v9
    v_lshlrev_b32 v8, 16, v9
    v_and_b32 v9, s22, v9
    v_mul_f32 v8, v8, v7
    v_mul_f32 v9, v9, v7
    v_cvt_pk_bf16_f32 v103, v8, v9
    buffer_store_dwordx4 v[100:103], v5, s[4:7], s21 offen
    s_add_u32 s21, s21, 1024
    v_lshlrev_b32 v8, 16, v88
    v_and_b32 v9, s22, v88
    v_sub_f32 v8, v8, v6
    v_sub_f32 v9, v9, v6
    v_cvt_pk_bf16_f32 v9, v8, v9
    v_lshlrev_b32 v8, 16, v9
    v_and_b32 v9, s22, v9
    v_mul_f32 v8, v8, v7
    v_mul_f32 v9, v9, v7
    v_cvt_pk_bf16_f32 v96, v8, v9
    v_lshlrev_b32 v8, 16, v90
    v_and_b32 v9, s22, v90
    v_sub_f32 v8, v8, v6
    v_sub_f32 v9, v9, v6
    v_cvt_pk_bf16_f32 v9, v8, v9
    v_lshlrev_b32 v8, 16, v9
    v_and_b32 v9, s22, v9
    v_mul_f32 v8, v8, v7
    v_mul_f32 v9, v9, v7
    v_cvt_pk_bf16_f32 v97, v8, v9
    v_lshlrev_b32 v8, 16, v89
    v_and_b32 v9, s22, v89
    v_sub_f32 v8, v8, v6
    v_sub_f32 v9, v9, v6
    v_cvt_pk_bf16_f32 v9, v8, v9
    v_lshlrev_b32 v8, 16, v9
    v_and_b32 v9, s22, v9
    v_mul_f32 v8, v8, v7
    v_mul_f32 v9, v9, v7
    v_cvt_pk_bf16_f32 v98, v8, v9
    v_lshlrev_b32 v8, 16, v91
    v_and_b32 v9, s22, v91
    v_sub_f32 v8, v8, v6
    v_sub_f32 v9, v9, v6
    v_cvt_pk_bf16_f32 v9, v8, v9
    v_lshlrev_b32 v8, 16, v9
    v_and_b32 v9, s22, v9
    v_mul_f32 v8, v8, v7
    v_mul_f32 v9, v9, v7
    v_cvt_pk_bf16_f32 v99, v8, v9
    buffer_store_dwordx4 v[96:99], v5, s[4:7], s21 offen
    s_add_u32 s21, s21, 1024
    v_lshlrev_b32 v8, 16, v92
    v_and_b32 v9, s22, v92
    v_sub_f32 v8, v8, v6
    v_sub_f32 v9, v9, v6
    v_cvt_pk_bf16_f32 v9, v8, v9
    v_lshlrev_b32 v8, 16, v9
    v_and_b32 v9, s22, v9
    v_mul_f32 v8, v8, v7
    v_mul_f32 v9, v9, v7
    v_cvt_pk_bf16_f32 v100, v8, v9
    v_lshlrev_b32 v8, 16, v94
    v_and_b32 v9, s22, v94
    v_sub_f32 v8, v8, v6
    v_sub_f32 v9, v9, v6
    v_cvt_pk_bf16_f32 v9, v8, v9
    v_lshlrev_b32 v8, 16, v9
    v_and_b32 v9, s22, v9
    v_mul_f32 v8, v8, v7
    v_mul_f32 v9, v9, v7
    v_cvt_pk_bf16_f32 v101, v8, v9
    v_lshlrev_b32 v8, 16, v93
    v_and_b32 v9, s22, v93
    v_sub_f32 v8, v8, v6
    v_sub_f32 v9, v9, v6
    v_cvt_pk_bf16_f32 v9, v8, v9
    v_lshlrev_b32 v8, 16, v9
    v_and_b32 v9, s22, v9
    v_mul_f32 v8, v8, v7
    v_mul_f32 v9, v9, v7
    v_cvt_pk_bf16_f32 v102, v8, v9
    v_lshlrev_b32 v8, 16, v95
    v_and_b32 v9, s22, v95
    v_sub_f32 v8, v8, v6
    v_sub_f32 v9, v9, v6
    v_cvt_pk_bf16_f32 v9, v8, v9
    v_lshlrev_b32 v8, 16, v9
    v_and_b32 v9, s22, v9
    v_mul_f32 v8, v8, v7
    v_mul_f32 v9, v9, v7
    v_cvt_pk_bf16_f32 v103, v8, v9
    buffer_store_dwordx4 v[100:103], v5, s[4:7], s21 offen
    s_add_u32 s21, s21, 1024
    s_endpgm
prep_noln:
    s_sub_u32 s2, s2, 128
    s_cmp_ge_u32 s2, 80
    s_cbranch_scc1 prep_w
    s_load_dwordx2 s[8:9], s[0:1], 8
    s_mov_b32 s10, 10240
    s_mov_b32 s11, 0x00020000
    s_lshl_b32 s20, s2, 14
    s_add_u32 s20, s20, 46147584
    v_lshlrev_b32 v2, 4, v0
    v_mov_b32 v4, -1
    v_mov_b32 v5, -1
    v_mov_b32 v6, -1
    v_mov_b32 v7, -1
    s_waitcnt lgkmcnt(0)
    buffer_store_dwordx4 v[4:7], v2, s[4:7], s20 offen
    s_add_u32 s20, s20, 4096
    buffer_store_dwordx4 v[4:7], v2, s[4:7], s20 offen
    s_add_u32 s20, s20, 4096
    buffer_store_dwordx4 v[4:7], v2, s[4:7], s20 offen
    s_add_u32 s20, s20, 4096
    buffer_store_dwordx4 v[4:7], v2, s[4:7], s20 offen
    s_add_u32 s20, s20, 4096
    s_cmp_ge_u32 s2, 3
    s_cbranch_scc1 prep_end
    s_lshl_b32 s20, s2, 8
    v_add_u32 v2, s20, v0
    v_cmp_gt_u32 vcc, 640, v2
    v_and_b32 v3, 7, v2
    v_lshrrev_b32 v4, 3, v2
    v_mul_u32_u24 v3, 1280, v3
    v_lshl_add_u32 v3, v4, 4, v3
    v_lshlrev_b32 v2, 4, v2
    s_mov_b32 s20, 46137344
    s_and_saveexec_b64 s[22:23], vcc
    s_cbranch_execz prep_end
    buffer_load_dwordx4 v[4:7], v3, s[8:11], 0 offen
    s_waitcnt vmcnt(0)
    buffer_store_dwordx4 v[4:7], v2, s[4:7], s20 offen
    s_endpgm
prep_w:
    s_sub_u32 s2, s2, 80
    s_cmp_ge_u32 s2, 320
    s_cbranch_scc1 prep_m0
    s_load_dwordx2 s[8:9], s[0:1], 16
    s_mov_b32 s10, 5242880
    s_mov_b32 s11, 0x00020000
    s_mov_b32 s12, 8192
    s_mov_b32 s13, 64
    s_mov_b32 s14, 67108864
    s_mov_b32 s15, 20480
    s_mov_b32 s16, 0
    s_mov_b32 s24, 2048
    s_mov_b32 s25, 512
    s_mov_b32 s26, 1024
    s_mov_b32 s27, 128
    s_mov_b32 s28, 256
    s_branch prep_go
prep_m0:
    s_sub_u32 s2, s2, 320
    s_cmp_ge_u32 s2, 320
    s_cbranch_scc1 prep_m1
    s_load_dwordx2 s[8:9], s[0:1], 24
    s_mov_b32 s10, 5242880
    s_mov_b32 s11, 0x00020000
    s_mov_b32 s12, 8192
    s_mov_b32 s13, 64
    s_mov_b32 s14, 67108864
    s_mov_b32 s15, 20480
    s_mov_b32 s16, 5242880
    s_mov_b32 s24, 2048
    s_mov_b32 s25, 512
    s_mov_b32 s26, 1024
    s_mov_b32 s27, 128
    s_mov_b32 s28, 256
    s_branch prep_go
prep_m1:
    s_sub_u32 s2, s2, 320
    s_cmp_ge_u32 s2, 320
    s_cbranch_scc1 prep_m2
    s_load_dwordx2 s[8:9], s[0:1], 32
    s_mov_b32 s10, 5242880
    s_mov_b32 s11, 0x00020000
    s_mov_b32 s12, 8192
    s_mov_b32 s13, 64
    s_mov_b32 s14, 67108864
    s_mov_b32 s15, 20480
    s_mov_b32 s16, 10485760
    s_mov_b32 s24, 2048
    s_mov_b32 s25, 512
    s_mov_b32 s26, 1024
    s_mov_b32 s27, 128
    s_mov_b32 s28, 256
    s_branch prep_go
prep_m2:
    s_sub_u32 s2, s2, 320
    s_cmp_ge_u32 s2, 320
    s_cbranch_scc1 prep_m3
    s_load_dwordx2 s[8:9], s[0:1], 40
    s_mov_b32 s10, 5242880
    s_mov_b32 s11, 0x00020000
    s_mov_b32 s12, 1280
    s_mov_b32 s13, 10
    s_mov_b32 s14, 429496730
    s_mov_b32 s15, 131072
    s_mov_b32 s16, 22020096
    s_mov_b32 s24, 1024
    s_mov_b32 s25, 2048
    s_mov_b32 s26, 512
    s_mov_b32 s27, 128
    s_mov_b32 s28, 256
    s_branch prep_go
prep_m3:
    s_sub_u32 s2, s2, 320
    s_branch prep_end
prep_go:
    s_lshl_b32 s2, s2, 2
    s_add_u32 s2, s2, s3
    s_mul_hi_u32 s17, s2, s14
    s_mul_i32 s18, s17, s13
    s_sub_u32 s18, s2, s18
    s_mul_i32 s19, s17, s12
    s_lshl_b32 s19, s19, 5
    s_lshl_b32 s20, s18, 7
    s_add_u32 s19, s19, s20
    s_lshl_b32 s20, s12, 3
    v_lshrrev_b32 v2, 3, v1
    v_and_b32 v3, 7, v1
    v_mul_lo_u32 v2, s12, v2
    v_lshl_add_u32 v2, v3, 4, v2
    s_waitcnt lgkmcnt(0)
    buffer_load_dwordx4 v[16:19], v2, s[8:11], s19 offen nt
    s_add_u32 s19, s19, s20
    buffer_load_dwordx4 v[20:23], v2, s[8:11], s19 offen nt
    s_add_u32 s19, s19, s20
    buffer_load_dwordx4 v[24:27], v2, s[8:11], s19 offen nt
    s_add_u32 s19, s19, s20
    buffer_load_dwordx4 v[28:31], v2, s[8:11], s19 offen nt
    s_add_u32 s19, s19, s20
    s_lshl_b32 s21, s3, 12
    v_lshlrev_b32 v5, 4, v1
    v_add_u32 v6, s21, v5
    v_and_b32 v7, 3, v1
    v_lshlrev_b32 v7, 3, v7
    v_add_u32 v7, s21, v7
    v_bfe_u32 v8, v1, 5, 1
    v_mul_lo_u32 v8, s24, v8
    v_add_u32 v7, v7, v8
    v_bfe_u32 v8, v1, 4, 1
    v_mul_lo_u32 v8, s25, v8
    v_add_u32 v7, v7, v8
    v_bfe_u32 v8, v1, 3, 1
    v_mul_lo_u32 v8, s26, v8
    v_add_u32 v7, v7, v8
    v_bfe_u32 v8, v1, 2, 1
    v_mul_lo_u32 v8, s27, v8
    v_add_u32 v7, v7, v8
    v_add_u32 v8, s28, v7
    s_lshl_b32 s18, s18, 2
    s_mul_i32 s18, s18, s15
    s_lshl_b32 s17, s17, 10
    s_add_u32 s18, s18, s17
    s_add_u32 s18, s18, s16
    s_waitcnt vmcnt(3)
    ds_write_b128 v6, v[16:19] offset:0
    s_waitcnt vmcnt(2)
    ds_write_b128 v6, v[20:23] offset:1024
    s_waitcnt vmcnt(1)
    ds_write_b128 v6, v[24:27] offset:2048
    s_waitcnt vmcnt(0)
    ds_write_b128 v6, v[28:31] offset:3072
    s_waitcnt lgkmcnt(0)
    ds_read_b64_tr_b16 v[32:33], v7 offset:0
    ds_read_b64_tr_b16 v[34:35], v8 offset:0
    ds_read_b64_tr_b16 v[36:37], v7 offset:32
    ds_read_b64_tr_b16 v[38:39], v8 offset:32
    ds_read_b64_tr_b16 v[40:41], v7 offset:64
    ds_read_b64_tr_b16 v[42:43], v8 offset:64
    ds_read_b64_tr_b16 v[44:45], v7 offset:96
    ds_read_b64_tr_b16 v[46:47], v8 offset:96
    s_waitcnt lgkmcnt(6)
    buffer_store_dwordx4 v[32:35], v5, s[4:7], s18 offen
    s_add_u32 s18, s18, s15
    s_waitcnt lgkmcnt(4)
    buffer_store_dwordx4 v[36:39], v5, s[4:7], s18 offen
    s_add_u32 s18, s18, s15
    s_waitcnt lgkmcnt(2)
    buffer_store_dwordx4 v[40:43], v5, s[4:7], s18 offen
    s_add_u32 s18, s18, s15
    s_waitcnt lgkmcnt(0)
    buffer_store_dwordx4 v[44:47], v5, s[4:7], s18 offen
    s_add_u32 s18, s18, s15
prep_end:
    s_endpgm
.text
.globl rec_kernel
.p2align 8
.type rec_kernel,@function
rec_kernel:
    s_load_dwordx2 s[4:5], s[0:1], 104
    s_mov_b32 s6, 268435456
    s_mov_b32 s7, 0x00020000
    s_load_dwordx2 s[8:9], s[0:1], 96
    s_mov_b32 s10, 256
    s_mov_b32 s11, 0x00020000
    v_lshrrev_b32 v1, 6, v0
    s_nop 0
    v_readfirstlane_b32 s3, v1
    v_and_b32 v1, 63, v0
    s_cmp_ge_u32 s2, 256
    s_cbranch_scc1 rec_exit
    s_mov_b32 s50, 0x200000
    s_lshr_b32 s14, s2, 3
    s_waitcnt lgkmcnt(0)
    s_and_b32 s40, s2, 7
    s_cbranch_scc1 rec_work
    s_getreg_b32 s15, hwreg(HW_REG_XCC_ID)
    s_and_b32 s15, s15, 7
    s_lshl_b32 s15, s15, 3
    s_lshl_b64 s[16:17], 1, s15
    v_mov_b32 v8, s16
    v_mov_b32 v9, s17
    v_mov_b32 v10, 0
    v_cmp_eq_u32 vcc, 0, v0
    s_and_saveexec_b64 s[18:19], vcc
    s_cbranch_execz rec_noat
    buffer_atomic_add_x2 v[8:9], v10, s[8:11], 0 offen sc1
rec_noat:
    s_mov_b64 exec, -1
    s_lshl_b32 s20, s14, 2
    s_add_u32 s20, s20, s3
    s_mul_i32 s40, s20, 40960
    s_mul_i32 s41, s3, 1310720
    s_lshl_b32 s21, s14, 12
    s_add_u32 s41, s41, s21
    s_add_u32 s41, s41, 22020096
    s_mul_i32 s43, s14, 260
    s_add_u32 s43, s43, s3
    s_lshl_b32 s42, s43, 12
    s_add_u32 s42, s42, 167772160
    s_lshl_b32 s52, s14, 11
    s_add_u32 s52, s52, 48234496
    s_lshl_b32 s43, s43, 11
    s_add_u32 s43, s43, 209715200
    s_mul_i32 s51, s3, 2560
    s_add_u32 s44, s51, 46137344
    s_lshl_b32 s21, s3, 5
    s_add_u32 s21, s21, s14
    s_lshl_b32 s45, s21, 7
    s_add_u32 s45, s45, 46147584
    s_lshl_b32 s47, s21, 12
    s_add_u32 s47, s47, 46792704
    s_cmp_lt_u32 s21, 80
    s_cselect_b32 s54, 1, 0
    s_mul_i32 s46, s3, 81920
    s_lshl_b32 s21, s14, 7
    s_add_u32 s46, s46, s21
    s_add_u32 s46, s46, 46792704
    s_mov_b32 s48, 0
    s_add_u32 s55, s46, 0
    s_add_u32 s56, s46, 16384
    s_add_u32 s57, s46, 32768
    s_add_u32 s58, s46, 49152
    s_add_u32 s59, s46, 65536
    s_mov_b32 s49, 0
    s_lshl_b32 s80, s20, 4
    s_add_u32 s80, s80, 47120384
    s_mov_b32 s81, -1
    s_mov_b32 s88, -2040
    s_add_u32 s84, s41, 0
    s_add_u32 s85, s41, 131072
    s_add_u32 s86, s41, 2048
    s_lshl_b32 s82, s14, 5
    s_add_u32 s82, s82, s3
    s_lshl_b32 s82, s82, 2
    s_add_u32 s82, s82, 47124480
    s_mov_b32 s53, 0x3e0293ee
    v_and_b32 v12, 7, v1
    v_lshrrev_b32 v13, 4, v1
    v_bfe_u32 v14, v1, 3, 1
    v_mov_b32 v2, 0x4444
    v_mov_b32 v15, 0xaaaa
    v_mad_u32_u24 v2, v14, v15, v2
    v_lshl_add_u32 v5, v13, 3, v12
    v_lshlrev_b32 v5, 4, v5
    v_lshl_add_u32 v6, v14, 11, v5
    s_lshl_b32 s21, s3, 9
    v_add_u32 v5, s21, v5
    v_lshl_add_u32 v5, v14, 18, v5
    v_and_b32 v15, 2, v13
    v_add_u32 v15, v15, v14
    v_lshlrev_b32 v4, 12, v15
    v_lshl_add_u32 v4, v12, 4, v4
    v_and_b32 v15, 1, v13
    v_lshl_add_u32 v4, v15, 3, v4
    v_lshlrev_b32 v1, 4, v1
    s_mul_i32 s21, s3, 36864
    s_add_u32 s21, s21, 16384
    v_add_u32 v3, s21, v1
    v_lshlrev_b32 v13, 2, v13
    v_sub_u32 v13, v12, v13
    v_mov_b32 v16, 0x3f80
    v_mov_b32 v17, 1.0
    v_mov_b32 v20, 0
    v_cmp_eq_i32 vcc, 0, v13
    s_nop 1
    v_cndmask_b32 v20, v20, v16, vcc
    v_cmp_eq_i32 vcc, 1, v13
    s_nop 1
    v_cndmask_b32 v20, v20, v17, vcc
    v_mov_b32 v21, 0
    v_cmp_eq_i32 vcc, 2, v13
    s_nop 1
    v_cndmask_b32 v21, v21, v16, vcc
    v_cmp_eq_i32 vcc, 3, v13
    s_nop 1
    v_cndmask_b32 v21, v21, v17, vcc
    v_mov_b32 v22, 0
    v_cmp_eq_i32 vcc, -8, v13
    s_nop 1
    v_cndmask_b32 v22, v22, v16, vcc
    v_cmp_eq_i32 vcc, -7, v13
    s_nop 1
    v_cndmask_b32 v22, v22, v17, vcc
    v_mov_b32 v23, 0
    v_cmp_eq_i32 vcc, -6, v13
    s_nop 1
    v_cndmask_b32 v23, v23, v16, vcc
    v_cmp_eq_i32 vcc, -5, v13
    s_nop 1
    v_cndmask_b32 v23, v23, v17, vcc
    v_mov_b32 v24, 0
    v_cmp_eq_i32 vcc, 0, v12
    s_nop 1
    v_cndmask_b32 v24, v24, v16, vcc
    v_cmp_eq_i32 vcc, 1, v12
    s_nop 1
    v_cndmask_b32 v24, v24, v17, vcc
    v_mov_b32 v25, 0
    v_cmp_eq_i32 vcc, 2, v12
    s_nop 1
    v_cndmask_b32 v25, v25, v16, vcc
    v_cmp_eq_i32 vcc, 3, v12
    s_nop 1
    v_cndmask_b32 v25, v25, v17, vcc
    v_mov_b32 v26, 0
    v_cmp_eq_i32 vcc, 4, v12
    s_nop 1
    v_cndmask_b32 v26, v26, v16, vcc
    v_cmp_eq_i32 vcc, 5, v12
    s_nop 1
    v_cndmask_b32 v26, v26, v17, vcc
    v_mov_b32 v27, 0
    v_cmp_eq_i32 vcc, 6, v12
    s_nop 1
    v_cndmask_b32 v27, v27, v16, vcc
    v_cmp_eq_i32 vcc, 7, v12
    s_nop 1
    v_cndmask_b32 v27, v27, v17, vcc
    buffer_store_dwordx4 v[20:23], v1, s[4:7], s52 offen
    buffer_store_dwordx4 v[24:27], v1, s[4:7], s52 offen offset:1024
    s_waitcnt vmcnt(0)
    s_add_u32 s12, s40, 0
    buffer_load_dwordx4 v[24:27], v1, s[4:7], s12 offen
    buffer_load_dwordx4 v[28:31], v1, s[4:7], s12 offen offset:1024
    s_add_u32 s12, s40, 20480
    buffer_load_dwordx4 v[40:43], v1, s[4:7], s12 offen
    buffer_load_dwordx4 v[44:47], v1, s[4:7], s12 offen offset:1024
    s_add_u32 s12, s40, 5242880
    buffer_load_dwordx4 v[8:11], v1, s[4:7], s12 offen
    buffer_load_dwordx4 v[12:15], v1, s[4:7], s12 offen offset:1024
    s_add_u32 s12, s40, 5263360
    buffer_load_dwordx4 v[16:19], v1, s[4:7], s12 offen
    buffer_load_dwordx4 v[20:23], v1, s[4:7], s12 offen offset:1024
    s_add_u32 s12, s40, 10485760
    buffer_load_dwordx4 v[80:83], v1, s[4:7], s12 offen
    buffer_load_dwordx4 v[84:87], v1, s[4:7], s12 offen offset:1024
    s_add_u32 s12, s40, 10506240
    buffer_load_dwordx4 v[88:91], v1, s[4:7], s12 offen
    buffer_load_dwordx4 v[92:95], v1, s[4:7], s12 offen offset:1024
    s_add_u32 s12, s40, 2048
    buffer_load_dwordx4 v[96:99], v1, s[4:7], s12 offen
    buffer_load_dwordx4 v[100:103], v1, s[4:7], s12 offen offset:1024
    s_add_u32 s12, s40, 22528
    buffer_load_dwordx4 v[104:107], v1, s[4:7], s12 offen
    buffer_load_dwordx4 v[108:111], v1, s[4:7], s12 offen offset:1024
    s_add_u32 s12, s40, 5244928
    buffer_load_dwordx4 v[112:115], v1, s[4:7], s12 offen
    buffer_load_dwordx4 v[116:119], v1, s[4:7], s12 offen offset:1024
    s_add_u32 s12, s40, 5265408
    buffer_load_dwordx4 v[120:123], v1, s[4:7], s12 offen
    buffer_load_dwordx4 v[124:127], v1, s[4:7], s12 offen offset:1024
    s_add_u32 s12, s40, 10487808
    buffer_load_dwordx4 v[128:131], v1, s[4:7], s12 offen
    buffer_load_dwordx4 v[132:135], v1, s[4:7], s12 offen offset:1024
    s_add_u32 s12, s40, 10508288
    buffer_load_dwordx4 v[136:139], v1, s[4:7], s12 offen
    buffer_load_dwordx4 v[140:143], v1, s[4:7], s12 offen offset:1024
    s_add_u32 s12, s40, 4096
    buffer_load_dwordx4 v[144:147], v1, s[4:7], s12 offen
    buffer_load_dwordx4 v[148:151], v1, s[4:7], s12 offen offset:1024
    s_add_u32 s22, s21, 0
    s_mov_b32 m0, s22
    s_add_u32 s12, s40, 24576
    buffer_load_dwordx4 v1, s[4:7], s12 offen lds
    buffer_load_dwordx4 v1, s[4:7], s12 offen offset:1024 lds
    s_add_u32 s12, s40, 5246976
    buffer_load_dwordx4 v[152:155], v1, s[4:7], s12 offen
    buffer_load_dwordx4 v[156:159], v1, s[4:7], s12 offen offset:1024
    s_add_u32 s12, s40, 5267456
    buffer_load_dwordx4 v[160:163], v1, s[4:7], s12 offen
    buffer_load_dwordx4 v[164:167], v1, s[4:7], s12 offen offset:1024
    s_add_u32 s12, s40, 10489856
    buffer_load_dwordx4 v[168:171], v1, s[4:7], s12 offen
    buffer_load_dwordx4 v[172:175], v1, s[4:7], s12 offen offset:1024
    s_add_u32 s12, s40, 10510336
    buffer_load_dwordx4 v[176:179], v1, s[4:7], s12 offen
    buffer_load_dwordx4 v[180:183], v1, s[4:7], s12 offen offset:1024
    s_add_u32 s12, s40, 6144
    buffer_load_dwordx4 v[184:187], v1, s[4:7], s12 offen
    buffer_load_dwordx4 v[188:191], v1, s[4:7], s12 offen offset:1024
    s_add_u32 s22, s21, 2048
    s_mov_b32 m0, s22
    s_add_u32 s12, s40, 26624
    buffer_load_dwordx4 v1, s[4:7], s12 offen lds
    buffer_load_dwordx4 v1, s[4:7], s12 offen offset:1024 lds
    s_add_u32 s12, s40, 5249024
    buffer_load_dwordx4 v[192:195], v1, s[4:7], s12 offen
    buffer_load_dwordx4 v[196:199], v1, s[4:7], s12 offen offset:1024
    s_add_u32 s22, s21, 4096
    s_mov_b32 m0, s22
    s_add_u32 s12, s40, 5269504
    buffer_load_dwordx4 v1, s[4:7], s12 offen lds
    buffer_load_dwordx4 v1, s[4:7], s12 offen offset:1024 lds
    s_add_u32 s12, s40, 10491904
    buffer_load_dwordx4 v[200:203], v1, s[4:7], s12 offen
    buffer_load_dwordx4 v[204:207], v1, s[4:7], s12 offen offset:1024
    s_add_u32 s12, s40, 10512384
    buffer_load_dwordx4 v[208:211], v1, s[4:7], s12 offen
    buffer_load_dwordx4 v[212:215], v1, s[4:7], s12 offen offset:1024
    s_add_u32 s12, s40, 8192
    buffer_load_dwordx4 v[216:219], v1, s[4:7], s12 offen
    buffer_load_dwordx4 v[220:223], v1, s[4:7], s12 offen offset:1024
    s_add_u32 s22, s21, 6144
    s_mov_b32 m0, s22
    s_add_u32 s12, s40, 28672
    buffer_load_dwordx4 v1, s[4:7], s12 offen lds
    buffer_load_dwordx4 v1, s[4:7], s12 offen offset:1024 lds
    s_add_u32 s12, s40, 5251072
    buffer_load_dwordx4 v[224:227], v1, s[4:7], s12 offen
    buffer_load_dwordx4 v[228:231], v1, s[4:7], s12 offen offset:1024
    s_add_u32 s12, s40, 5271552
    buffer_load_dwordx4 v[232:235], v1, s[4:7], s12 offen
    buffer_load_dwordx4 v[236:239], v1, s[4:7], s12 offen offset:1024
    s_add_u32 s12, s40, 10493952
    buffer_load_dwordx4 v[240:243], v1, s[4:7], s12 offen
    buffer_load_dwordx4 v[244:247], v1, s[4:7], s12 offen offset:1024
    s_add_u32 s12, s40, 10514432
    buffer_load_dwordx4 v[248:251], v1, s[4:7], s12 offen
    buffer_load_dwordx4 v[252:255], v1, s[4:7], s12 offen offset:1024
    s_add_u32 s12, s40, 10240
    buffer_load_dwordx4 a[0:3], v1, s[4:7], s12 offen
    buffer_load_dwordx4 a[4:7], v1, s[4:7], s12 offen offset:1024
    s_add_u32 s22, s21, 8192
    s_mov_b32 m0, s22
    s_add_u32 s12, s40, 30720
    buffer_load_dwordx4 v1, s[4:7], s12 offen lds
    buffer_load_dwordx4 v1, s[4:7], s12 offen offset:1024 lds
    s_add_u32 s12, s40, 5253120
    buffer_load_dwordx4 a[8:11], v1, s[4:7], s12 offen
    buffer_load_dwordx4 a[12:15], v1, s[4:7], s12 offen offset:1024
    s_add_u32 s22, s21, 10240
    s_mov_b32 m0, s22
    s_add_u32 s12, s40, 5273600
    buffer_load_dwordx4 v1, s[4:7], s12 offen lds
    buffer_load_dwordx4 v1, s[4:7], s12 offen offset:1024 lds
    s_add_u32 s12, s40, 10496000
    buffer_load_dwordx4 a[16:19], v1, s[4:7], s12 offen
    buffer_load_dwordx4 a[20:23], v1, s[4:7], s12 offen offset:1024
    s_add_u32 s12, s40, 10516480
    buffer_load_dwordx4 a[24:27], v1, s[4:7], s12 offen
    buffer_load_dwordx4 a[28:31], v1, s[4:7], s12 offen offset:1024
    s_add_u32 s12, s40, 12288
    buffer_load_dwordx4 a[32:35], v1, s[4:7], s12 offen
    buffer_load_dwordx4 a[36:39], v1, s[4:7], s12 offen offset:1024
    s_add_u32 s22, s21, 12288
    s_mov_b32 m0, s22
    s_add_u32 s12, s40, 32768
    buffer_load_dwordx4 v1, s[4:7], s12 offen lds
    buffer_load_dwordx4 v1, s[4:7], s12 offen offset:1024 lds
    s_add_u32 s12, s40, 5255168
    buffer_load_dwordx4 a[40:43], v1, s[4:7], s12 offen
    buffer_load_dwordx4 a[44:47], v1, s[4:7], s12 offen offset:1024
    s_add_u32 s12, s40, 5275648
    buffer_load_dwordx4 a[48:51], v1, s[4:7], s12 offen
    buffer_load_dwordx4 a[52:55], v1, s[4:7], s12 offen offset:1024
    s_add_u32 s12, s40, 10498048
    buffer_load_dwordx4 a[56:59], v1, s[4:7], s12 offen
    buffer_load_dwordx4 a[60:63], v1, s[4:7], s12 offen offset:1024
    s_add_u32 s12, s40, 10518528
    buffer_load_dwordx4 a[64:67], v1, s[4:7], s12 offen
    buffer_load_dwordx4 a[68:71], v1, s[4:7], s12 offen offset:1024
    s_add_u32 s12, s40, 14336
    buffer_load_dwordx4 a[72:75], v1, s[4:7], s12 offen
    buffer_load_dwordx4 a[76:79], v1, s[4:7], s12 offen offset:1024
    s_add_u32 s22, s21, 14336
    s_mov_b32 m0, s22
    s_add_u32 s12, s40, 34816
    buffer_load_dwordx4 v1, s[4:7], s12 offen lds
    buffer_load_dwordx4 v1, s[4:7], s12 offen offset:1024 lds
    s_add_u32 s12, s40, 5257216
    buffer_load_dwordx4 a[80:83], v1, s[4:7], s12 offen
    buffer_load_dwordx4 a[84:87], v1, s[4:7], s12 offen offset:1024
    s_add_u32 s22, s21, 16384
    s_mov_b32 m0, s22
    s_add_u32 s12, s40, 5277696
    buffer_load_dwordx4 v1, s[4:7], s12 offen lds
    buffer_load_dwordx4 v1, s[4:7], s12 offen offset:1024 lds
    s_add_u32 s12, s40, 10500096
    buffer_load_dwordx4 a[88:91], v1, s[4:7], s12 offen
    buffer_load_dwordx4 a[92:95], v1, s[4:7], s12 offen offset:1024
    s_add_u32 s12, s40, 10520576
    buffer_load_dwordx4 a[96:99], v1, s[4:7], s12 offen
    buffer_load_dwordx4 a[100:103], v1, s[4:7], s12 offen offset:1024
    s_add_u32 s12, s40, 16384
    buffer_load_dwordx4 a[104:107], v1, s[4:7], s12 offen
    buffer_load_dwordx4 a[108:111], v1, s[4:7], s12 offen offset:1024
    s_add_u32 s22, s21, 18432
    s_mov_b32 m0, s22
    s_add_u32 s12, s40, 36864
    buffer_load_dwordx4 v1, s[4:7], s12 offen lds
    buffer_load_dwordx4 v1, s[4:7], s12 offen offset:1024 lds
    s_add_u32 s12, s40, 5259264
    buffer_load_dwordx4 a[112:115], v1, s[4:7], s12 offen
    buffer_load_dwordx4 a[116:119], v1, s[4:7], s12 offen offset:1024
    s_add_u32 s22, s21, 20480
    s_mov_b32 m0, s22
    s_add_u32 s12, s40, 5279744
    buffer_load_dwordx4 v1, s[4:7], s12 offen lds
    buffer_load_dwordx4 v1, s[4:7], s12 offen offset:1024 lds
    s_add_u32 s12, s40, 10502144
    buffer_load_dwordx4 a[120:123], v1, s[4:7], s12 offen
    buffer_load_dwordx4 a[124:127], v1, s[4:7], s12 offen offset:1024
    s_add_u32 s12, s40, 10522624
    buffer_load_dwordx4 a[128:131], v1, s[4:7], s12 offen
    buffer_load_dwordx4 a[132:135], v1, s[4:7], s12 offen offset:1024
    s_add_u32 s22, s21, 22528
    s_mov_b32 m0, s22
    s_add_u32 s12, s40, 38912
    buffer_load_dwordx4 v1, s[4:7], s12 offen lds
    buffer_load_dwordx4 v1, s[4:7], s12 offen offset:1024 lds
    s_add_u32 s12, s40, 5261312
    buffer_load_dwordx4 a[136:139], v1, s[4:7], s12 offen
    buffer_load_dwordx4 a[140:143], v1, s[4:7], s12 offen offset:1024
    s_add_u32 s12, s40, 5281792
    buffer_load_dwordx4 a[144:147], v1, s[4:7], s12 offen
    buffer_load_dwordx4 a[148:151], v1, s[4:7], s12 offen offset:1024
    s_add_u32 s12, s40, 10504192
    buffer_load_dwordx4 a[152:155], v1, s[4:7], s12 offen
    buffer_load_dwordx4 a[156:159], v1, s[4:7], s12 offen offset:1024
    s_add_u32 s12, s40, 10524672
    buffer_load_dwordx4 a[160:163], v1, s[4:7], s12 offen
    buffer_load_dwordx4 a[164:167], v1, s[4:7], s12 offen offset:1024
    s_add_u32 s22, s21, 24576
    s_mov_b32 m0, s22
    s_add_u32 s12, s41, 133120
    buffer_load_dwordx4 v1, s[4:7], s12 offen lds
    buffer_load_dwordx4 v1, s[4:7], s12 offen offset:1024 lds
    s_add_u32 s12, s41, 262144
    buffer_load_dwordx4 a[168:171], v1, s[4:7], s12 offen
    buffer_load_dwordx4 a[172:175], v1, s[4:7], s12 offen offset:1024
    s_add_u32 s12, s41, 393216
    buffer_load_dwordx4 a[176:179], v1, s[4:7], s12 offen
    buffer_load_dwordx4 a[180:183], v1, s[4:7], s12 offen offset:1024
    s_add_u32 s22, s21, 26624
    s_mov_b32 m0, s22
    s_add_u32 s12, s41, 264192
    buffer_load_dwordx4 v1, s[4:7], s12 offen lds
    buffer_load_dwordx4 v1, s[4:7], s12 offen offset:1024 lds
    s_add_u32 s12, s41, 395264
    buffer_load_dwordx4 a[184:187], v1, s[4:7], s12 offen
    buffer_load_dwordx4 a[188:191], v1, s[4:7], s12 offen offset:1024
    s_add_u32 s12, s41, 524288
    buffer_load_dwordx4 a[192:195], v1, s[4:7], s12 offen
    buffer_load_dwordx4 a[196:199], v1, s[4:7], s12 offen offset:1024
    s_add_u32 s22, s21, 28672
    s_mov_b32 m0, s22
    s_add_u32 s12, s41, 655360
    buffer_load_dwordx4 v1, s[4:7], s12 offen lds
    buffer_load_dwordx4 v1, s[4:7], s12 offen offset:1024 lds
    s_add_u32 s12, s41, 526336
    buffer_load_dwordx4 a[200:203], v1, s[4:7], s12 offen
    buffer_load_dwordx4 a[204:207], v1, s[4:7], s12 offen offset:1024
    s_add_u32 s12, s41, 657408
    buffer_load_dwordx4 a[208:211], v1, s[4:7], s12 offen
    buffer_load_dwordx4 a[212:215], v1, s[4:7], s12 offen offset:1024
    s_add_u32 s22, s21, 30720
    s_mov_b32 m0, s22
    s_add_u32 s12, s41, 786432
    buffer_load_dwordx4 v1, s[4:7], s12 offen lds
    buffer_load_dwordx4 v1, s[4:7], s12 offen offset:1024 lds
    s_add_u32 s12, s41, 917504
    buffer_load_dwordx4 a[216:219], v1, s[4:7], s12 offen
    buffer_load_dwordx4 a[220:223], v1, s[4:7], s12 offen offset:1024
    s_add_u32 s12, s41, 788480
    buffer_load_dwordx4 a[224:227], v1, s[4:7], s12 offen
    buffer_load_dwordx4 a[228:231], v1, s[4:7], s12 offen offset:1024
    s_add_u32 s22, s21, 32768
    s_mov_b32 m0, s22
    s_add_u32 s12, s41, 919552
    buffer_load_dwordx4 v1, s[4:7], s12 offen lds
    buffer_load_dwordx4 v1, s[4:7], s12 offen offset:1024 lds
    s_add_u32 s12, s41, 1048576
    buffer_load_dwordx4 a[232:235], v1, s[4:7], s12 offen
    buffer_load_dwordx4 a[236:239], v1, s[4:7], s12 offen offset:1024
    s_add_u32 s12, s41, 1179648
    buffer_load_dwordx4 a[240:243], v1, s[4:7], s12 offen
    buffer_load_dwordx4 a[244:247], v1, s[4:7], s12 offen offset:1024
    s_add_u32 s22, s21, 34816
    s_mov_b32 m0, s22
    s_add_u32 s12, s41, 1050624
    buffer_load_dwordx4 v1, s[4:7], s12 offen lds
    buffer_load_dwordx4 v1, s[4:7], s12 offen offset:1024 lds
    s_add_u32 s12, s41, 1181696
    buffer_load_dwordx4 a[248:251], v1, s[4:7], s12 offen
    buffer_load_dwordx4 a[252:255], v1, s[4:7], s12 offen offset:1024
    v_mov_b32 v0, 0
rec_hs:
    s_sub_u32 s50, s50, 1
    s_cbranch_scc1 rec_end
    buffer_load_dwordx2 v[76:77], v0, s[8:11], 0 offen sc1
    s_waitcnt vmcnt(0)
    v_readfirstlane_b32 s16, v76
    v_readfirstlane_b32 s17, v77
    s_add_u32 s18, s16, s17
    s_mul_i32 s18, s18, 0x01010101
    s_lshr_b32 s18, s18, 24
    s_cmp_lt_u32 s18, 32
    s_cbranch_scc1 rec_hs
rec_kv0:
    s_sub_u32 s50, s50, 1
    s_cbranch_scc1 rec_end
    buffer_load_dwordx4 v[64:67], off, s[4:7], s80 sc1
    s_waitcnt vmcnt(0)
    v_min3_i32 v64, v64, v65, v66
    v_min_i32 v64, v64, v67
    s_nop 1
    v_readfirstlane_b32 s81, v64
    s_sub_i32 s81, s81, 1
    s_cmp_gt_i32 s81, s49
    s_cbranch_scc0 rec_kv0
    s_lshr_b64 s[16:17], s[16:17], s15
    s_and_b32 s16, s16, 0xff
    s_cmp_eq_u32 s16, 32
    s_cbranch_scc0 recs_loop
recf_loop:
    s_cmp_gt_i32 s81, s49
    s_cbranch_scc1 recf_kvok
recf_kvw:
    s_sub_u32 s50, s50, 1
    s_cbranch_scc1 rec_end
    buffer_load_dwordx4 v[64:67], off, s[4:7], s80 sc1
    s_waitcnt vmcnt(0)
    v_min3_i32 v64, v64, v65, v66
    v_min_i32 v64, v64, v67
    s_nop 1
    v_readfirstlane_b32 s81, v64
    s_sub_i32 s81, s81, 1
    s_cmp_gt_i32 s81, s49
    s_cbranch_scc0 recf_kvw
recf_kvok:
recf_pg:
    s_sub_u32 s50, s50, 1
    s_cbranch_scc1 rec_end
    buffer_load_dwordx4 v[64:67], v1, s[4:7], s44 offen offset:0 sc1
    buffer_load_dwordx4 v[68:71], v1, s[4:7], s44 offen offset:1024 sc1
    buffer_load_dwordx4 v[72:75], v1, s[4:7], s44 offen offset:1536 sc1
    s_waitcnt vmcnt(0)
    v_max3_u32 v7, v64, v65, v66
    v_max3_u32 v7, v7, v67, v68
    v_max3_u32 v7, v7, v69, v70
    v_max3_u32 v7, v7, v71, v72
    v_max3_u32 v7, v7, v73, v74
    v_max_u32 v7, v7, v75
    v_cmp_eq_u32 vcc, -1, v7
    s_cbranch_vccnz recf_pg
    v_add_u32 v7, s51, v1
    ds_write_b128 v7, v[64:67] offset:0
    ds_write_b128 v7, v[68:71] offset:1024
    ds_write_b128 v7, v[72:75] offset:1536
    v_mov_b64 v[56:57], 0
    v_mov_b64 v[58:59], 0
    v_mov_b64 v[60:61], 0
    v_mov_b64 v[62:63], 0
    s_waitcnt lgkmcnt(0)
    s_barrier
    ds_read_b128 v[52:55], v1 offset:0
    ds_read_b128 v[76:79], v1 offset:1024
    ds_read_b128 v[48:51], v1 offset:2048
    v_mov_b64 v[64:65], 0
    v_mov_b64 v[66:67], 0
    v_mov_b64 v[68:69], 0
    v_mov_b64 v[70:71], 0
    buffer_load_dwordx4 v[72:75], v1, s[4:7], s52 offen
    s_waitcnt lgkmcnt(2)
    v_smfmac_f32_16x16x64_bf16 v[56:59], v[52:55], v[24:31], v2
    s_add_u32 s12, s40, 18432
    buffer_load_dwordx4 v[24:27], v1, s[4:7], s12 offen
    buffer_load_dwordx4 v[28:31], v1, s[4:7], s12 offen offset:1024
    v_smfmac_f32_16x16x64_bf16 v[60:63], v[52:55], v[40:47], v2
    ds_read_b128 v[40:43], v3 offset:0
    ds_read_b128 v[44:47], v3 offset:1024
    buffer_load_dwordx4 v[32:35], v1, s[4:7], s42 offen offset:0 nt
    v_smfmac_f32_16x16x64_bf16 v[64:67], v[52:55], v[8:15], v2
    ds_read_b128 v[8:11], v3 offset:2048
    ds_read_b128 v[12:15], v3 offset:3072
    buffer_load_dwordx4 v[36:39], v1, s[4:7], s42 offen offset:1024 nt
    v_smfmac_f32_16x16x64_bf16 v[68:71], v[52:55], v[16:23], v2
    ds_read_b128 v[16:19], v3 offset:4096
    ds_read_b128 v[20:23], v3 offset:5120
    ds_read_b128 v[52:55], v1 offset:3072
    s_waitcnt lgkmcnt(8)
    v_smfmac_f32_16x16x64_bf16 v[56:59], v[76:79], v[96:103], v2
    v_smfmac_f32_16x16x64_bf16 v[60:63], v[76:79], v[104:111], v2
    v_smfmac_f32_16x16x64_bf16 v[64:67], v[76:79], v[112:119], v2
    v_smfmac_f32_16x16x64_bf16 v[68:71], v[76:79], v[120:127], v2
    ds_read_b128 v[76:79], v1 offset:4096
    s_waitcnt lgkmcnt(8)
    v_smfmac_f32_16x16x64_bf16 v[56:59], v[48:51], v[144:151], v2
    s_waitcnt lgkmcnt(6)
    v_smfmac_f32_16x16x64_bf16 v[60:63], v[48:51], v[40:47], v2
    ds_read_b128 v[40:43], v3 offset:6144
    ds_read_b128 v[44:47], v3 offset:7168
    v_smfmac_f32_16x16x64_bf16 v[64:67], v[48:51], v[152:159], v2
    v_smfmac_f32_16x16x64_bf16 v[68:71], v[48:51], v[160:167], v2
    ds_read_b128 v[48:51], v1 offset:5120
    s_waitcnt lgkmcnt(4)
    v_smfmac_f32_16x16x64_bf16 v[56:59], v[52:55], v[184:191], v2
    v_smfmac_f32_16x16x64_bf16 v[60:63], v[52:55], v[8:15], v2
    ds_read_b128 v[8:11], v3 offset:8192
    ds_read_b128 v[12:15], v3 offset:9216
    v_smfmac_f32_16x16x64_bf16 v[64:67], v[52:55], v[192:199], v2
    v_smfmac_f32_16x16x64_bf16 v[68:71], v[52:55], v[16:23], v2
    ds_read_b128 v[16:19], v3 offset:10240
    ds_read_b128 v[20:23], v3 offset:11264
    ds_read_b128 v[52:55], v1 offset:6144
    s_waitcnt lgkmcnt(8)
    v_smfmac_f32_16x16x64_bf16 v[56:59], v[76:79], v[216:223], v2
    s_waitcnt lgkmcnt(6)
    v_smfmac_f32_16x16x64_bf16 v[60:63], v[76:79], v[40:47], v2
    ds_read_b128 v[40:43], v3 offset:12288
    ds_read_b128 v[44:47], v3 offset:13312
    v_smfmac_f32_16x16x64_bf16 v[64:67], v[76:79], v[224:231], v2
    v_smfmac_f32_16x16x64_bf16 v[68:71], v[76:79], v[232:239], v2
    ds_read_b128 v[76:79], v1 offset:7168
    s_waitcnt lgkmcnt(8)
    v_smfmac_f32_16x16x64_bf16 v[56:59], v[48:51], a[0:7], v2
    s_waitcnt lgkmcnt(6)
    v_smfmac_f32_16x16x64_bf16 v[60:63], v[48:51], v[8:15], v2
    ds_read_b128 v[8:11], v3 offset:14336
    ds_read_b128 v[12:15], v3 offset:15360
    v_smfmac_f32_16x16x64_bf16 v[64:67], v[48:51], a[8:15], v2
    s_waitcnt lgkmcnt(6)
    v_smfmac_f32_16x16x64_bf16 v[68:71], v[48:51], v[16:23], v2
    ds_read_b128 v[16:19], v3 offset:16384
    ds_read_b128 v[20:23], v3 offset:17408
    ds_read_b128 v[48:51], v1 offset:8192
    s_waitcnt lgkmcnt(8)
    v_smfmac_f32_16x16x64_bf16 v[56:59], v[52:55], a[32:39], v2
    s_waitcnt lgkmcnt(6)
    v_smfmac_f32_16x16x64_bf16 v[60:63], v[52:55], v[40:47], v2
    ds_read_b128 v[40:43], v3 offset:18432
    ds_read_b128 v[44:47], v3 offset:19456
    v_smfmac_f32_16x16x64_bf16 v[64:67], v[52:55], a[40:47], v2
    v_smfmac_f32_16x16x64_bf16 v[68:71], v[52:55], a[48:55], v2
    ds_read_b128 v[52:55], v1 offset:9216
    s_waitcnt lgkmcnt(8)
    v_smfmac_f32_16x16x64_bf16 v[56:59], v[76:79], a[72:79], v2
    s_waitcnt lgkmcnt(6)
    v_smfmac_f32_16x16x64_bf16 v[60:63], v[76:79], v[8:15], v2
    ds_read_b128 v[8:11], v3 offset:20480
    ds_read_b128 v[12:15], v3 offset:21504
    v_smfmac_f32_16x16x64_bf16 v[64:67], v[76:79], a[80:87], v2
    s_waitcnt lgkmcnt(6)
    v_smfmac_f32_16x16x64_bf16 v[68:71], v[76:79], v[16:23], v2
    ds_read_b128 v[16:19], v3 offset:22528
    ds_read_b128 v[20:23], v3 offset:23552
    s_waitcnt lgkmcnt(7)
    v_smfmac_f32_16x16x64_bf16 v[56:59], v[48:51], a[104:111], v2
    s_waitcnt lgkmcnt(5)
    v_smfmac_f32_16x16x64_bf16 v[60:63], v[48:51], v[40:47], v2
    buffer_load_dwordx4 v[40:43], v1, s[4:7], s42 offen offset:2048 nt
    buffer_load_dwordx4 v[44:47], v1, s[4:7], s42 offen offset:3072 nt
    v_smfmac_f32_16x16x64_bf16 v[64:67], v[48:51], a[112:119], v2
    s_waitcnt lgkmcnt(2)
    v_smfmac_f32_16x16x64_bf16 v[68:71], v[48:51], v[8:15], v2
    s_waitcnt vmcnt(4)
    v_smfmac_f32_16x16x64_bf16 v[56:59], v[52:55], v[24:31], v2
    v_mov_b64 v[24:25], 0
    v_mov_b64 v[26:27], 0
    s_waitcnt lgkmcnt(0)
    v_smfmac_f32_16x16x64_bf16 v[60:63], v[52:55], v[16:23], v2
    v_mov_b64 v[28:29], 0
    v_mov_b64 v[30:31], 0
    v_smfmac_f32_16x16x64_bf16 v[64:67], v[52:55], a[136:143], v2
    v_smfmac_f32_16x16x64_bf16 v[68:71], v[52:55], a[144:151], v2
    v_smfmac_f32_16x16x64_bf16 v[24:27], v[48:51], a[120:127], v2
    v_smfmac_f32_16x16x64_bf16 v[28:31], v[48:51], a[128:135], v2
    v_smfmac_f32_16x16x64_bf16 v[24:27], v[52:55], a[152:159], v2
    v_smfmac_f32_16x16x64_bf16 v[28:31], v[52:55], a[160:167], v2
    ds_read_b128 v[48:51], v1 offset:0
    ds_read_b128 v[52:55], v1 offset:1024
    v_permlane32_swap_b32 v56, v60
    v_permlane32_swap_b32 v57, v61
    v_permlane32_swap_b32 v58, v62
    v_permlane32_swap_b32 v59, v63
    v_pk_add_f32 v[56:57], v[56:57], v[60:61]
    v_pk_add_f32 v[58:59], v[58:59], v[62:63]
    v_cvt_pk_bf16_f32 v60, v56, v57
    v_cvt_pk_bf16_f32 v61, v58, v59
    v_permlane32_swap_b32 v64, v68
    v_permlane32_swap_b32 v65, v69
    v_permlane32_swap_b32 v66, v70
    v_permlane32_swap_b32 v67, v71
    v_pk_add_f32 v[64:65], v[64:65], v[68:69]
    v_pk_add_f32 v[66:67], v[66:67], v[70:71]
    v_cvt_pk_bf16_f32 v68, v64, v65
    v_cvt_pk_bf16_f32 v69, v66, v67
    v_mfma_f32_16x16x16_bf16 v[8:11], v[60:61], v[72:73], 0
    v_mfma_f32_16x16x16_bf16 v[12:15], v[60:61], v[74:75], 0
    v_mfma_f32_16x16x16_bf16 v[16:19], v[68:69], v[72:73], 0
    v_mfma_f32_16x16x16_bf16 v[20:23], v[68:69], v[74:75], 0
    s_waitcnt lgkmcnt(1)
    v_smfmac_f32_16x16x64_bf16 v[24:27], v[48:51], v[80:87], v2
    v_smfmac_f32_16x16x64_bf16 v[28:31], v[48:51], v[88:95], v2
    s_waitcnt lgkmcnt(0)
    v_smfmac_f32_16x16x64_bf16 v[24:27], v[52:55], v[128:135], v2
    v_smfmac_f32_16x16x64_bf16 v[28:31], v[52:55], v[136:143], v2
    ds_read_b128 v[48:51], v1 offset:2048
    ds_read_b128 v[52:55], v1 offset:3072
    v_cvt_pk_bf16_f32 v56, v8, v9
    v_cvt_pk_bf16_f32 v57, v10, v11
    v_cvt_pk_bf16_f32 v58, v12, v13
    v_cvt_pk_bf16_f32 v59, v14, v15
    v_cvt_pk_bf16_f32 v60, v16, v17
    v_cvt_pk_bf16_f32 v61, v18, v19
    v_cvt_pk_bf16_f32 v62, v20, v21
    v_cvt_pk_bf16_f32 v63, v22, v23
    v_lshrrev_b32 v7, 11, v6
    v_mad_i32_i24 v7, v7, s88, v6
    v_mfma_f32_16x16x32_bf16 v[64:67], v[60:63], v[56:59], 0
    s_waitcnt vmcnt(3)
    v_mfma_f32_16x16x32_bf16 v[68:71], v[32:35], v[56:59], 0
    s_waitcnt vmcnt(2)
    v_mfma_f32_16x16x32_bf16 v[72:75], v[36:39], v[56:59], 0
    s_nop 2
    buffer_store_dwordx4 v[60:63], v1, s[4:7], s43 offen sc1 nt
    s_waitcnt lgkmcnt(1)
    v_smfmac_f32_16x16x64_bf16 v[24:27], v[48:51], v[168:175], v2
    ds_write_b128 v5, v[64:67] offset:10240
    ds_write_b128 v5, v[68:71] offset:12288
    ds_write_b128 v5, v[72:75] offset:14336
    v_smfmac_f32_16x16x64_bf16 v[28:31], v[48:51], v[176:183], v2
    s_waitcnt lgkmcnt(3)
    v_smfmac_f32_16x16x64_bf16 v[24:27], v[52:55], v[200:207], v2
    v_smfmac_f32_16x16x64_bf16 v[28:31], v[52:55], v[208:215], v2
    s_waitcnt lgkmcnt(0)
    s_barrier
    ds_read_b128 v[56:59], v6 offset:12288
    ds_read_b128 v[60:63], v6 offset:12800
    ds_read_b128 v[64:67], v6 offset:13312
    ds_read_b128 v[68:71], v6 offset:13824
    ds_read_b64 v[72:73], v7 offset:10240
    ds_read_b64 v[74:75], v7 offset:10752
    ds_read_b64 v[76:77], v7 offset:11264
    ds_read_b64 v[78:79], v7 offset:11776
    ds_read_b128 v[48:51], v1 offset:4096
    ds_read_b128 v[52:55], v1 offset:5120
    buffer_load_dwordx4 v[8:11], v1, s[4:7], s84 offen offset:0
    buffer_load_dwordx4 v[12:15], v1, s[4:7], s84 offen offset:1024
    s_waitcnt lgkmcnt(8)
    v_pk_add_f32 v[56:57], v[56:57], v[60:61]
    v_pk_add_f32 v[58:59], v[58:59], v[62:63]
    s_waitcnt lgkmcnt(6)
    v_pk_add_f32 v[64:65], v[64:65], v[68:69]
    v_pk_add_f32 v[66:67], v[66:67], v[70:71]
    v_pk_add_f32 v[56:57], v[56:57], v[64:65]
    v_pk_add_f32 v[58:59], v[58:59], v[66:67]
    buffer_load_dwordx4 v[16:19], v1, s[4:7], s85 offen offset:0
    s_waitcnt lgkmcnt(2)
    v_pk_add_f32 v[72:73], v[72:73], v[74:75]
    v_pk_add_f32 v[76:77], v[76:77], v[78:79]
    v_pk_add_f32 v[72:73], v[72:73], v[76:77]
    v_max3_f32 v60, v56, v57, v58
    v_max3_f32 v60, v60, v59, v72
    v_max_f32 v60, v60, v73
    s_waitcnt lgkmcnt(1)
    v_smfmac_f32_16x16x64_bf16 v[24:27], v[48:51], v[240:247], v2
    buffer_load_dwordx4 v[20:23], v1, s[4:7], s85 offen offset:1024
    v_smfmac_f32_16x16x64_bf16 v[28:31], v[48:51], v[248:255], v2
    ds_read_b128 v[48:51], v1 offset:6144
    v_max_f32_dpp v60, v60, v60 row_ror:8 row_mask:0xf bank_mask:0xf
    v_mov_b32 v61, v60
    s_waitcnt lgkmcnt(1)
    v_smfmac_f32_16x16x64_bf16 v[24:27], v[52:55], a[16:23], v2
    buffer_load_dwordx4 v[32:35], v1, s[4:7], s86 offen offset:0
    v_smfmac_f32_16x16x64_bf16 v[28:31], v[52:55], a[24:31], v2
    v_permlane32_swap_b32 v61, v60
    v_max_f32 v60, v60, v61
    v_mov_b32 v61, v60
    ds_read_b128 v[52:55], v1 offset:7168
    buffer_load_dwordx4 v[36:39], v1, s[4:7], s86 offen offset:1024
    v_permlane16_swap_b32 v61, v60
    v_max_f32 v60, v60, v61
    v_mul_f32 v61, 0xbe0293ee, v60
    v_pk_fma_f32 v[56:57], v[56:57], s[52:53], v[60:61] op_sel:[0,1,1] op_sel_hi:[1,1,1]
    v_pk_fma_f32 v[58:59], v[58:59], s[52:53], v[60:61] op_sel:[0,1,1] op_sel_hi:[1,1,1]
    v_pk_fma_f32 v[72:73], v[72:73], s[52:53], v[60:61] op_sel:[0,1,1] op_sel_hi:[1,1,1]
    s_waitcnt lgkmcnt(1)
    v_smfmac_f32_16x16x64_bf16 v[24:27], v[48:51], a[56:63], v2
    v_exp_f32 v56, v56
    v_smfmac_f32_16x16x64_bf16 v[28:31], v[48:51], a[64:71], v2
    v_exp_f32 v57, v57
    s_waitcnt lgkmcnt(0)
    v_smfmac_f32_16x16x64_bf16 v[24:27], v[52:55], a[88:95], v2
    s_add_u32 s13, s45, 10240
    v_exp_f32 v58, v58
    v_smfmac_f32_16x16x64_bf16 v[28:31], v[52:55], a[96:103], v2
    buffer_load_dword v7, off, s[4:7], s13
    v_exp_f32 v59, v59
    v_exp_f32 v72, v72
    v_exp_f32 v73, v73
    v_cvt_pk_bf16_f32 v64, v56, v57
    v_cvt_pk_bf16_f32 v65, v58, v59
    v_cvt_pk_bf16_f32 v68, v72, v73
    v_mov_b32_dpp v66, v64 row_ror:8 row_mask:0xf bank_mask:0xf
    v_mov_b32_dpp v67, v65 row_ror:8 row_mask:0xf bank_mask:0xf
    v_mov_b32_dpp v69, v68 row_ror:8 row_mask:0xf bank_mask:0xf
    v_cvt_pk_bf16_f32 v48, v24, v25
    v_cvt_pk_bf16_f32 v49, v26, v27
    v_cvt_pk_bf16_f32 v50, v28, v29
    v_cvt_pk_bf16_f32 v51, v30, v31
    s_waitcnt vmcnt(8)
    v_mfma_f32_16x16x32_bf16 v[24:27], v[40:43], v[64:67], 0
    v_mfma_f32_16x16x32_bf16 v[28:31], v[44:47], v[64:67], 0
    v_mov_b32 v0, s49
    buffer_store_dword v0, off, s[4:7], s82 sc1
    v_add_f32 v56, v56, v57
    v_add_f32 v58, v58, v59
    v_add_f32 v72, v72, v73
    v_add_f32 v60, v56, v58
    v_fmac_f32 v60, 0.5, v72
    v_mfma_f32_16x16x16_bf16 v[24:27], v[48:49], v[68:69], v[24:27]
    v_mfma_f32_16x16x16_bf16 v[28:31], v[50:51], v[68:69], v[28:31]
    v_add_f32_dpp v60, v60, v60 row_ror:8 row_mask:0xf bank_mask:0xf
    v_mov_b32 v61, v60
    ds_read_b128 v[40:43], v3 offset:24576
    ds_read_b128 v[44:47], v3 offset:25600
    v_permlane32_swap_b32 v61, v60
    v_add_f32 v60, v60, v61
    v_mov_b32 v61, v60
    buffer_store_dwordx4 v[48:51], v1, s[4:7], s43 offen offset:1024 sc1 nt
    s_cmp_eq_u32 s49, 63
    v_permlane16_swap_b32 v61, v60
    v_add_f32 v60, v60, v61
    v_rcp_f32 v60, v60
    s_cbranch_scc1 rec_end
    v_pk_mul_f32 v[24:25], v[24:25], v[60:61] op_sel_hi:[1,0]
    v_pk_mul_f32 v[26:27], v[26:27], v[60:61] op_sel_hi:[1,0]
    v_pk_mul_f32 v[28:29], v[28:29], v[60:61] op_sel_hi:[1,0]
    v_pk_mul_f32 v[30:31], v[30:31], v[60:61] op_sel_hi:[1,0]
    v_cvt_pk_bf16_f32 v76, v24, v25
    v_cvt_pk_bf16_f32 v77, v26, v27
    v_cvt_pk_bf16_f32 v78, v28, v29
    v_cvt_pk_bf16_f32 v79, v30, v31
    ds_write_b128 v5, v[76:79]
    ds_read_b128 v[24:27], v3 offset:26624
    ds_read_b128 v[28:31], v3 offset:27648
    v_mov_b64 v[56:57], 0
    v_mov_b64 v[58:59], 0
    v_mov_b64 v[60:61], 0
    v_mov_b64 v[62:63], 0
    v_mov_b64 v[64:65], 0
    v_mov_b64 v[66:67], 0
    v_mov_b64 v[68:69], 0
    v_mov_b64 v[70:71], 0
    s_waitcnt lgkmcnt(2)
    s_barrier
    ds_read_b128 v[48:51], v1 offset:0
    ds_read_b128 v[52:55], v1 offset:1024
    v_mov_b64 v[72:73], 0
    v_mov_b64 v[74:75], 0
    v_mov_b64 v[76:77], 0
    v_mov_b64 v[78:79], 0
    s_waitcnt vmcnt(3)
    s_waitcnt lgkmcnt(1)
    v_smfmac_f32_16x16x64_bf16 v[56:59], v[48:51], v[8:15], v2
    s_add_u32 s42, s42, 16384
    v_smfmac_f32_16x16x64_bf16 v[60:63], v[48:51], v[16:23], v2
    s_waitcnt lgkmcnt(0)
    v_smfmac_f32_16x16x64_bf16 v[56:59], v[52:55], v[32:39], v2
    v_smfmac_f32_16x16x64_bf16 v[60:63], v[52:55], v[40:47], v2
    ds_read_b128 v[40:43], v3 offset:28672
    ds_read_b128 v[44:47], v3 offset:29696
    v_smfmac_f32_16x16x64_bf16 v[64:67], v[48:51], a[168:175], v2
    v_smfmac_f32_16x16x64_bf16 v[68:71], v[48:51], a[176:183], v2
    v_smfmac_f32_16x16x64_bf16 v[64:67], v[52:55], v[24:31], v2
    ds_read_b128 v[24:27], v3 offset:30720
    ds_read_b128 v[28:31], v3 offset:31744
    v_smfmac_f32_16x16x64_bf16 v[68:71], v[52:55], a[184:191], v2
    v_smfmac_f32_16x16x64_bf16 v[72:75], v[48:51], a[192:199], v2
    v_permlane32_swap_b32 v56, v60
    v_permlane32_swap_b32 v57, v61
    v_permlane32_swap_b32 v58, v62
    v_permlane32_swap_b32 v59, v63
    s_waitcnt lgkmcnt(2)
    v_smfmac_f32_16x16x64_bf16 v[76:79], v[48:51], v[40:47], v2
    ds_read_b128 v[40:43], v3 offset:32768
    ds_read_b128 v[44:47], v3 offset:33792
    v_pk_add_f32 v[56:57], v[56:57], v[60:61]
    v_pk_add_f32 v[58:59], v[58:59], v[62:63]
    v_cvt_pk_bf16_f32 v60, v56, v57
    v_cvt_pk_bf16_f32 v61, v58, v59
    v_smfmac_f32_16x16x64_bf16 v[72:75], v[52:55], a[200:207], v2
    v_and_or_b32 v60, v60, -2, s48
    buffer_store_dwordx2 v[60:61], v4, s[4:7], s55 offen
    v_mov_b64 v[56:57], 0
    v_mov_b64 v[58:59], 0
    v_smfmac_f32_16x16x64_bf16 v[76:79], v[52:55], a[208:215], v2
    v_mov_b64 v[62:63], 0
    v_mov_b64 v[60:61], 0
    s_waitcnt lgkmcnt(2)
    v_smfmac_f32_16x16x64_bf16 v[56:59], v[48:51], v[24:31], v2
    ds_read_b128 v[24:27], v3 offset:34816
    ds_read_b128 v[28:31], v3 offset:35840
    v_permlane32_swap_b32 v64, v68
    v_permlane32_swap_b32 v65, v69
    v_permlane32_swap_b32 v66, v70
    v_permlane32_swap_b32 v67, v71
    v_smfmac_f32_16x16x64_bf16 v[60:63], v[48:51], a[216:223], v2
    v_pk_add_f32 v[64:65], v[64:65], v[68:69]
    v_pk_add_f32 v[66:67], v[66:67], v[70:71]
    v_cvt_pk_bf16_f32 v68, v64, v65
    v_cvt_pk_bf16_f32 v69, v66, v67
    v_smfmac_f32_16x16x64_bf16 v[56:59], v[52:55], a[224:231], v2
    v_and_or_b32 v68, v68, -2, s48
    buffer_store_dwordx2 v[68:69], v4, s[4:7], s56 offen
    v_mov_b64 v[64:65], 0
    v_mov_b64 v[66:67], 0
    s_waitcnt lgkmcnt(2)
    v_smfmac_f32_16x16x64_bf16 v[60:63], v[52:55], v[40:47], v2
    v_mov_b64 v[70:71], 0
    v_mov_b64 v[68:69], 0
    v_smfmac_f32_16x16x64_bf16 v[64:67], v[48:51], a[232:239], v2
    v_permlane32_swap_b32 v72, v76
    v_permlane32_swap_b32 v73, v77
    v_permlane32_swap_b32 v74, v78
    v_smfmac_f32_16x16x64_bf16 v[68:71], v[48:51], a[240:247], v2
    v_permlane32_swap_b32 v75, v79
    v_pk_add_f32 v[72:73], v[72:73], v[76:77]
    v_pk_add_f32 v[74:75], v[74:75], v[78:79]
    s_waitcnt lgkmcnt(0)
    v_smfmac_f32_16x16x64_bf16 v[64:67], v[52:55], v[24:31], v2
    v_cvt_pk_bf16_f32 v76, v72, v73
    v_cvt_pk_bf16_f32 v77, v74, v75
    v_and_or_b32 v76, v76, -2, s48
    v_smfmac_f32_16x16x64_bf16 v[68:71], v[52:55], a[248:255], v2
    buffer_store_dwordx2 v[76:77], v4, s[4:7], s57 offen
    v_permlane32_swap_b32 v56, v60
    v_permlane32_swap_b32 v57, v61
    v_permlane32_swap_b32 v58, v62
    v_permlane32_swap_b32 v59, v63
    v_pk_add_f32 v[56:57], v[56:57], v[60:61]
    v_pk_add_f32 v[58:59], v[58:59], v[62:63]
    v_cvt_pk_bf16_f32 v60, v56, v57
    v_cvt_pk_bf16_f32 v61, v58, v59
    v_and_or_b32 v60, v60, -2, s48
    buffer_store_dwordx2 v[60:61], v4, s[4:7], s58 offen
    v_permlane32_swap_b32 v64, v68
    v_permlane32_swap_b32 v65, v69
    v_permlane32_swap_b32 v66, v70
    v_permlane32_swap_b32 v67, v71
    v_pk_add_f32 v[64:65], v[64:65], v[68:69]
    v_pk_add_f32 v[66:67], v[66:67], v[70:71]
    v_cvt_pk_bf16_f32 v68, v64, v65
    v_cvt_pk_bf16_f32 v69, v66, v67
    v_and_or_b32 v68, v68, -2, s48
    buffer_store_dwordx2 v[68:69], v4, s[4:7], s59 offen
    s_add_u32 s12, s40, 5242880
    buffer_load_dwordx4 v[8:11], v1, s[4:7], s12 offen
    buffer_load_dwordx4 v[12:15], v1, s[4:7], s12 offen offset:1024
    s_add_u32 s12, s40, 5263360
    buffer_load_dwordx4 v[16:19], v1, s[4:7], s12 offen
    buffer_load_dwordx4 v[20:23], v1, s[4:7], s12 offen offset:1024
    s_cmp_eq_u32 s54, 0
    s_cbranch_scc1 recf_nored
    buffer_load_dwordx4 v[72:75], v1, s[4:7], s52 offen offset:1024
    v_bfe_u32 v52, v1, 9, 1
    v_and_b32 v53, 0xff, v4
    v_lshl_add_u32 v52, v52, 2, v53
recf_pr:
    s_sub_u32 s50, s50, 1
    s_cbranch_scc1 rec_end
    buffer_load_dwordx4 v[56:59], v1, s[4:7], s47 offen offset:0 sc1
    buffer_load_dwordx4 v[60:63], v1, s[4:7], s47 offen offset:1024 sc1
    buffer_load_dwordx4 v[64:67], v1, s[4:7], s47 offen offset:2048 sc1
    buffer_load_dwordx4 v[68:71], v1, s[4:7], s47 offen offset:3072 sc1
    s_waitcnt vmcnt(0)
    v_xor_b32 v7, s48, v56
    v_bitop3_b32 v7, v58, v7, s48 bitop3:0xde
    v_bitop3_b32 v7, v60, v7, s48 bitop3:0xde
    v_bitop3_b32 v7, v62, v7, s48 bitop3:0xde
    v_bitop3_b32 v7, v64, v7, s48 bitop3:0xde
    v_bitop3_b32 v7, v66, v7, s48 bitop3:0xde
    v_bitop3_b32 v7, v68, v7, s48 bitop3:0xde
    v_bitop3_b32 v7, v70, v7, s48 bitop3:0xde
    v_and_b32 v7, 1, v7
    v_cmp_ne_u32 vcc, 0, v7
    s_cbranch_vccnz recf_pr
    v_mfma_f32_16x16x32_bf16 v[76:79], v[56:59], v[72:75], 0
    v_mfma_f32_16x16x32_bf16 v[76:79], v[60:63], v[72:75], v[76:79]
    v_mfma_f32_16x16x32_bf16 v[76:79], v[64:67], v[72:75], v[76:79]
    v_mfma_f32_16x16x32_bf16 v[76:79], v[68:71], v[72:75], v[76:79]
    s_nop 7
    v_permlane32_swap_b32 v76, v78
    v_permlane32_swap_b32 v77, v79
    v_pk_add_f32 v[76:77], v[76:77], v[78:79]
    v_cvt_pk_bf16_f32 v76, v76, v77
    v_min_u32 v76, -2, v76
    buffer_store_dword v76, v52, s[4:7], s45 offen
recf_nored:
    s_add_u32 s43, s43, 8192
    s_add_u32 s44, s44, 10240
    s_add_u32 s45, s45, 10240
    s_xor_b32 s48, s48, 1
    s_add_u32 s49, s49, 1
    s_barrier
    s_add_u32 s12, s40, 20480
    buffer_load_dwordx4 v[40:43], v1, s[4:7], s12 offen
    buffer_load_dwordx4 v[44:47], v1, s[4:7], s12 offen offset:1024
    s_add_u32 s12, s40, 0
    buffer_load_dwordx4 v[24:27], v1, s[4:7], s12 offen
    buffer_load_dwordx4 v[28:31], v1, s[4:7], s12 offen offset:1024
    s_branch recf_loop
recs_loop:
    s_cmp_gt_i32 s81, s49
    s_cbranch_scc1 recs_kvok
recs_kvw:
    s_sub_u32 s50, s50, 1
    s_cbranch_scc1 rec_end
    buffer_load_dwordx4 v[64:67], off, s[4:7], s80 sc1
    s_waitcnt vmcnt(0)
    v_min3_i32 v64, v64, v65, v66
    v_min_i32 v64, v64, v67
    s_nop 1
    v_readfirstlane_b32 s81, v64
    s_sub_i32 s81, s81, 1
    s_cmp_gt_i32 s81, s49
    s_cbranch_scc0 recs_kvw
recs_kvok:
recs_pg:
    s_sub_u32 s50, s50, 1
    s_cbranch_scc1 rec_end
    buffer_load_dwordx4 v[64:67], v1, s[4:7], s44 offen offset:0 sc1
    buffer_load_dwordx4 v[68:71], v1, s[4:7], s44 offen offset:1024 sc1
    buffer_load_dwordx4 v[72:75], v1, s[4:7], s44 offen offset:1536 sc1
    s_waitcnt vmcnt(0)
    v_max3_u32 v7, v64, v65, v66
    v_max3_u32 v7, v7, v67, v68
    v_max3_u32 v7, v7, v69, v70
    v_max3_u32 v7, v7, v71, v72
    v_max3_u32 v7, v7, v73, v74
    v_max_u32 v7, v7, v75
    v_cmp_eq_u32 vcc, -1, v7
    s_cbranch_vccnz recs_pg
    v_add_u32 v7, s51, v1
    ds_write_b128 v7, v[64:67] offset:0
    ds_write_b128 v7, v[68:71] offset:1024
    ds_write_b128 v7, v[72:75] offset:1536
    v_mov_b64 v[56:57], 0
    v_mov_b64 v[58:59], 0
    v_mov_b64 v[60:61], 0
    v_mov_b64 v[62:63], 0
    s_waitcnt lgkmcnt(0)
    s_barrier
    ds_read_b128 v[52:55], v1 offset:0
    ds_read_b128 v[76:79], v1 offset:1024
    ds_read_b128 v[48:51], v1 offset:2048
    v_mov_b64 v[64:65], 0
    v_mov_b64 v[66:67], 0
    v_mov_b64 v[68:69], 0
    v_mov_b64 v[70:71], 0
    buffer_load_dwordx4 v[72:75], v1, s[4:7], s52 offen
    s_waitcnt lgkmcnt(2)
    v_smfmac_f32_16x16x64_bf16 v[56:59], v[52:55], v[24:31], v2
    s_add_u32 s12, s40, 18432
    buffer_load_dwordx4 v[24:27], v1, s[4:7], s12 offen
    buffer_load_dwordx4 v[28:31], v1, s[4:7], s12 offen offset:1024
    v_smfmac_f32_16x16x64_bf16 v[60:63], v[52:55], v[40:47], v2
    ds_read_b128 v[40:43], v3 offset:0
    ds_read_b128 v[44:47], v3 offset:1024
    buffer_load_dwordx4 v[32:35], v1, s[4:7], s42 offen offset:0 nt
    v_smfmac_f32_16x16x64_bf16 v[64:67], v[52:55], v[8:15], v2
    ds_read_b128 v[8:11], v3 offset:2048
    ds_read_b128 v[12:15], v3 offset:3072
    buffer_load_dwordx4 v[36:39], v1, s[4:7], s42 offen offset:1024 nt
    v_smfmac_f32_16x16x64_bf16 v[68:71], v[52:55], v[16:23], v2
    ds_read_b128 v[16:19], v3 offset:4096
    ds_read_b128 v[20:23], v3 offset:5120
    ds_read_b128 v[52:55], v1 offset:3072
    s_waitcnt lgkmcnt(8)
    v_smfmac_f32_16x16x64_bf16 v[56:59], v[76:79], v[96:103], v2
    v_smfmac_f32_16x16x64_bf16 v[60:63], v[76:79], v[104:111], v2
    v_smfmac_f32_16x16x64_bf16 v[64:67], v[76:79], v[112:119], v2
    v_smfmac_f32_16x16x64_bf16 v[68:71], v[76:79], v[120:127], v2
    ds_read_b128 v[76:79], v1 offset:4096
    s_waitcnt lgkmcnt(8)
    v_smfmac_f32_16x16x64_bf16 v[56:59], v[48:51], v[144:151], v2
    s_waitcnt lgkmcnt(6)
    v_smfmac_f32_16x16x64_bf16 v[60:63], v[48:51], v[40:47], v2
    ds_read_b128 v[40:43], v3 offset:6144
    ds_read_b128 v[44:47], v3 offset:7168
    v_smfmac_f32_16x16x64_bf16 v[64:67], v[48:51], v[152:159], v2
    v_smfmac_f32_16x16x64_bf16 v[68:71], v[48:51], v[160:167], v2
    ds_read_b128 v[48:51], v1 offset:5120
    s_waitcnt lgkmcnt(4)
    v_smfmac_f32_16x16x64_bf16 v[56:59], v[52:55], v[184:191], v2
    v_smfmac_f32_16x16x64_bf16 v[60:63], v[52:55], v[8:15], v2
    ds_read_b128 v[8:11], v3 offset:8192
    ds_read_b128 v[12:15], v3 offset:9216
    v_smfmac_f32_16x16x64_bf16 v[64:67], v[52:55], v[192:199], v2
    v_smfmac_f32_16x16x64_bf16 v[68:71], v[52:55], v[16:23], v2
    ds_read_b128 v[16:19], v3 offset:10240
    ds_read_b128 v[20:23], v3 offset:11264
    ds_read_b128 v[52:55], v1 offset:6144
    s_waitcnt lgkmcnt(8)
    v_smfmac_f32_16x16x64_bf16 v[56:59], v[76:79], v[216:223], v2
    s_waitcnt lgkmcnt(6)
    v_smfmac_f32_16x16x64_bf16 v[60:63], v[76:79], v[40:47], v2
    ds_read_b128 v[40:43], v3 offset:12288
    ds_read_b128 v[44:47], v3 offset:13312
    v_smfmac_f32_16x16x64_bf16 v[64:67], v[76:79], v[224:231], v2
    v_smfmac_f32_16x16x64_bf16 v[68:71], v[76:79], v[232:239], v2
    ds_read_b128 v[76:79], v1 offset:7168
    s_waitcnt lgkmcnt(8)
    v_smfmac_f32_16x16x64_bf16 v[56:59], v[48:51], a[0:7], v2
    s_waitcnt lgkmcnt(6)
    v_smfmac_f32_16x16x64_bf16 v[60:63], v[48:51], v[8:15], v2
    ds_read_b128 v[8:11], v3 offset:14336
    ds_read_b128 v[12:15], v3 offset:15360
    v_smfmac_f32_16x16x64_bf16 v[64:67], v[48:51], a[8:15], v2
    s_waitcnt lgkmcnt(6)
    v_smfmac_f32_16x16x64_bf16 v[68:71], v[48:51], v[16:23], v2
    ds_read_b128 v[16:19], v3 offset:16384
    ds_read_b128 v[20:23], v3 offset:17408
    ds_read_b128 v[48:51], v1 offset:8192
    s_waitcnt lgkmcnt(8)
    v_smfmac_f32_16x16x64_bf16 v[56:59], v[52:55], a[32:39], v2
    s_waitcnt lgkmcnt(6)
    v_smfmac_f32_16x16x64_bf16 v[60:63], v[52:55], v[40:47], v2
    ds_read_b128 v[40:43], v3 offset:18432
    ds_read_b128 v[44:47], v3 offset:19456
    v_smfmac_f32_16x16x64_bf16 v[64:67], v[52:55], a[40:47], v2
    v_smfmac_f32_16x16x64_bf16 v[68:71], v[52:55], a[48:55], v2
    ds_read_b128 v[52:55], v1 offset:9216
    s_waitcnt lgkmcnt(8)
    v_smfmac_f32_16x16x64_bf16 v[56:59], v[76:79], a[72:79], v2
    s_waitcnt lgkmcnt(6)
    v_smfmac_f32_16x16x64_bf16 v[60:63], v[76:79], v[8:15], v2
    ds_read_b128 v[8:11], v3 offset:20480
    ds_read_b128 v[12:15], v3 offset:21504
    v_smfmac_f32_16x16x64_bf16 v[64:67], v[76:79], a[80:87], v2
    s_waitcnt lgkmcnt(6)
    v_smfmac_f32_16x16x64_bf16 v[68:71], v[76:79], v[16:23], v2
    ds_read_b128 v[16:19], v3 offset:22528
    ds_read_b128 v[20:23], v3 offset:23552
    s_waitcnt lgkmcnt(7)
    v_smfmac_f32_16x16x64_bf16 v[56:59], v[48:51], a[104:111], v2
    s_waitcnt lgkmcnt(5)
    v_smfmac_f32_16x16x64_bf16 v[60:63], v[48:51], v[40:47], v2
    buffer_load_dwordx4 v[40:43], v1, s[4:7], s42 offen offset:2048 nt
    buffer_load_dwordx4 v[44:47], v1, s[4:7], s42 offen offset:3072 nt
    v_smfmac_f32_16x16x64_bf16 v[64:67], v[48:51], a[112:119], v2
    s_waitcnt lgkmcnt(2)
    v_smfmac_f32_16x16x64_bf16 v[68:71], v[48:51], v[8:15], v2
    s_waitcnt vmcnt(4)
    v_smfmac_f32_16x16x64_bf16 v[56:59], v[52:55], v[24:31], v2
    v_mov_b64 v[24:25], 0
    v_mov_b64 v[26:27], 0
    s_waitcnt lgkmcnt(0)
    v_smfmac_f32_16x16x64_bf16 v[60:63], v[52:55], v[16:23], v2
    v_mov_b64 v[28:29], 0
    v_mov_b64 v[30:31], 0
    v_smfmac_f32_16x16x64_bf16 v[64:67], v[52:55], a[136:143], v2
    v_smfmac_f32_16x16x64_bf16 v[68:71], v[52:55], a[144:151], v2
    v_smfmac_f32_16x16x64_bf16 v[24:27], v[48:51], a[120:127], v2
    v_smfmac_f32_16x16x64_bf16 v[28:31], v[48:51], a[128:135], v2
    v_smfmac_f32_16x16x64_bf16 v[24:27], v[52:55], a[152:159], v2
    v_smfmac_f32_16x16x64_bf16 v[28:31], v[52:55], a[160:167], v2
    ds_read_b128 v[48:51], v1 offset:0
    ds_read_b128 v[52:55], v1 offset:1024
    v_permlane32_swap_b32 v56, v60
    v_permlane32_swap_b32 v57, v61
    v_permlane32_swap_b32 v58, v62
    v_permlane32_swap_b32 v59, v63
    v_pk_add_f32 v[56:57], v[56:57], v[60:61]
    v_pk_add_f32 v[58:59], v[58:59], v[62:63]
    v_cvt_pk_bf16_f32 v60, v56, v57
    v_cvt_pk_bf16_f32 v61, v58, v59
    v_permlane32_swap_b32 v64, v68
    v_permlane32_swap_b32 v65, v69
    v_permlane32_swap_b32 v66, v70
    v_permlane32_swap_b32 v67, v71
    v_pk_add_f32 v[64:65], v[64:65], v[68:69]
    v_pk_add_f32 v[66:67], v[66:67], v[70:71]
    v_cvt_pk_bf16_f32 v68, v64, v65
    v_cvt_pk_bf16_f32 v69, v66, v67
    v_mfma_f32_16x16x16_bf16 v[8:11], v[60:61], v[72:73], 0
    v_mfma_f32_16x16x16_bf16 v[12:15], v[60:61], v[74:75], 0
    v_mfma_f32_16x16x16_bf16 v[16:19], v[68:69], v[72:73], 0
    v_mfma_f32_16x16x16_bf16 v[20:23], v[68:69], v[74:75], 0
    s_waitcnt lgkmcnt(1)
    v_smfmac_f32_16x16x64_bf16 v[24:27], v[48:51], v[80:87], v2
    v_smfmac_f32_16x16x64_bf16 v[28:31], v[48:51], v[88:95], v2
    s_waitcnt lgkmcnt(0)
    v_smfmac_f32_16x16x64_bf16 v[24:27], v[52:55], v[128:135], v2
    v_smfmac_f32_16x16x64_bf16 v[28:31], v[52:55], v[136:143], v2
    ds_read_b128 v[48:51], v1 offset:2048
    ds_read_b128 v[52:55], v1 offset:3072
    v_cvt_pk_bf16_f32 v56, v8, v9
    v_cvt_pk_bf16_f32 v57, v10, v11
    v_cvt_pk_bf16_f32 v58, v12, v13
    v_cvt_pk_bf16_f32 v59, v14, v15
    v_cvt_pk_bf16_f32 v60, v16, v17
    v_cvt_pk_bf16_f32 v61, v18, v19
    v_cvt_pk_bf16_f32 v62, v20, v21
    v_cvt_pk_bf16_f32 v63, v22, v23
    v_lshrrev_b32 v7, 11, v6
    v_mad_i32_i24 v7, v7, s88, v6
    v_mfma_f32_16x16x32_bf16 v[64:67], v[60:63], v[56:59], 0
    s_waitcnt vmcnt(3)
    v_mfma_f32_16x16x32_bf16 v[68:71], v[32:35], v[56:59], 0
    s_waitcnt vmcnt(2)
    v_mfma_f32_16x16x32_bf16 v[72:75], v[36:39], v[56:59], 0
    s_nop 2
    buffer_store_dwordx4 v[60:63], v1, s[4:7], s43 offen sc1 nt
    s_waitcnt lgkmcnt(1)
    v_smfmac_f32_16x16x64_bf16 v[24:27], v[48:51], v[168:175], v2
    ds_write_b128 v5, v[64:67] offset:10240
    ds_write_b128 v5, v[68:71] offset:12288
    ds_write_b128 v5, v[72:75] offset:14336
    v_smfmac_f32_16x16x64_bf16 v[28:31], v[48:51], v[176:183], v2
    s_waitcnt lgkmcnt(3)
    v_smfmac_f32_16x16x64_bf16 v[24:27], v[52:55], v[200:207], v2
    v_smfmac_f32_16x16x64_bf16 v[28:31], v[52:55], v[208:215], v2
    s_waitcnt lgkmcnt(0)
    s_barrier
    ds_read_b128 v[56:59], v6 offset:12288
    ds_read_b128 v[60:63], v6 offset:12800
    ds_read_b128 v[64:67], v6 offset:13312
    ds_read_b128 v[68:71], v6 offset:13824
    ds_read_b64 v[72:73], v7 offset:10240
    ds_read_b64 v[74:75], v7 offset:10752
    ds_read_b64 v[76:77], v7 offset:11264
    ds_read_b64 v[78:79], v7 offset:11776
    ds_read_b128 v[48:51], v1 offset:4096
    ds_read_b128 v[52:55], v1 offset:5120
    buffer_load_dwordx4 v[8:11], v1, s[4:7], s84 offen offset:0
    buffer_load_dwordx4 v[12:15], v1, s[4:7], s84 offen offset:1024
    s_waitcnt lgkmcnt(8)
    v_pk_add_f32 v[56:57], v[56:57], v[60:61]
    v_pk_add_f32 v[58:59], v[58:59], v[62:63]
    s_waitcnt lgkmcnt(6)
    v_pk_add_f32 v[64:65], v[64:65], v[68:69]
    v_pk_add_f32 v[66:67], v[66:67], v[70:71]
    v_pk_add_f32 v[56:57], v[56:57], v[64:65]
    v_pk_add_f32 v[58:59], v[58:59], v[66:67]
    buffer_load_dwordx4 v[16:19], v1, s[4:7], s85 offen offset:0
    s_waitcnt lgkmcnt(2)
    v_pk_add_f32 v[72:73], v[72:73], v[74:75]
    v_pk_add_f32 v[76:77], v[76:77], v[78:79]
    v_pk_add_f32 v[72:73], v[72:73], v[76:77]
    v_max3_f32 v60, v56, v57, v58
    v_max3_f32 v60, v60, v59, v72
    v_max_f32 v60, v60, v73
    s_waitcnt lgkmcnt(1)
    v_smfmac_f32_16x16x64_bf16 v[24:27], v[48:51], v[240:247], v2
    buffer_load_dwordx4 v[20:23], v1, s[4:7], s85 offen offset:1024
    v_smfmac_f32_16x16x64_bf16 v[28:31], v[48:51], v[248:255], v2
    ds_read_b128 v[48:51], v1 offset:6144
    v_max_f32_dpp v60, v60, v60 row_ror:8 row_mask:0xf bank_mask:0xf
    v_mov_b32 v61, v60
    s_waitcnt lgkmcnt(1)
    v_smfmac_f32_16x16x64_bf16 v[24:27], v[52:55], a[16:23], v2
    buffer_load_dwordx4 v[32:35], v1, s[4:7], s86 offen offset:0
    v_smfmac_f32_16x16x64_bf16 v[28:31], v[52:55], a[24:31], v2
    v_permlane32_swap_b32 v61, v60
    v_max_f32 v60, v60, v61
    v_mov_b32 v61, v60
    ds_read_b128 v[52:55], v1 offset:7168
    buffer_load_dwordx4 v[36:39], v1, s[4:7], s86 offen offset:1024
    v_permlane16_swap_b32 v61, v60
    v_max_f32 v60, v60, v61
    v_mul_f32 v61, 0xbe0293ee, v60
    v_pk_fma_f32 v[56:57], v[56:57], s[52:53], v[60:61] op_sel:[0,1,1] op_sel_hi:[1,1,1]
    v_pk_fma_f32 v[58:59], v[58:59], s[52:53], v[60:61] op_sel:[0,1,1] op_sel_hi:[1,1,1]
    v_pk_fma_f32 v[72:73], v[72:73], s[52:53], v[60:61] op_sel:[0,1,1] op_sel_hi:[1,1,1]
    s_waitcnt lgkmcnt(1)
    v_smfmac_f32_16x16x64_bf16 v[24:27], v[48:51], a[56:63], v2
    v_exp_f32 v56, v56
    v_smfmac_f32_16x16x64_bf16 v[28:31], v[48:51], a[64:71], v2
    v_exp_f32 v57, v57
    s_waitcnt lgkmcnt(0)
    v_smfmac_f32_16x16x64_bf16 v[24:27], v[52:55], a[88:95], v2
    s_add_u32 s13, s45, 10240
    v_exp_f32 v58, v58
    v_smfmac_f32_16x16x64_bf16 v[28:31], v[52:55], a[96:103], v2
    buffer_load_dword v7, off, s[4:7], s13
    v_exp_f32 v59, v59
    v_exp_f32 v72, v72
    v_exp_f32 v73, v73
    v_cvt_pk_bf16_f32 v64, v56, v57
    v_cvt_pk_bf16_f32 v65, v58, v59
    v_cvt_pk_bf16_f32 v68, v72, v73
    v_mov_b32_dpp v66, v64 row_ror:8 row_mask:0xf bank_mask:0xf
    v_mov_b32_dpp v67, v65 row_ror:8 row_mask:0xf bank_mask:0xf
    v_mov_b32_dpp v69, v68 row_ror:8 row_mask:0xf bank_mask:0xf
    v_cvt_pk_bf16_f32 v48, v24, v25
    v_cvt_pk_bf16_f32 v49, v26, v27
    v_cvt_pk_bf16_f32 v50, v28, v29
    v_cvt_pk_bf16_f32 v51, v30, v31
    s_waitcnt vmcnt(8)
    v_mfma_f32_16x16x32_bf16 v[24:27], v[40:43], v[64:67], 0
    v_mfma_f32_16x16x32_bf16 v[28:31], v[44:47], v[64:67], 0
    v_mov_b32 v0, s49
    buffer_store_dword v0, off, s[4:7], s82 sc1
    v_add_f32 v56, v56, v57
    v_add_f32 v58, v58, v59
    v_add_f32 v72, v72, v73
    v_add_f32 v60, v56, v58
    v_fmac_f32 v60, 0.5, v72
    v_mfma_f32_16x16x16_bf16 v[24:27], v[48:49], v[68:69], v[24:27]
    v_mfma_f32_16x16x16_bf16 v[28:31], v[50:51], v[68:69], v[28:31]
    v_add_f32_dpp v60, v60, v60 row_ror:8 row_mask:0xf bank_mask:0xf
    v_mov_b32 v61, v60
    ds_read_b128 v[40:43], v3 offset:24576
    ds_read_b128 v[44:47], v3 offset:25600
    v_permlane32_swap_b32 v61, v60
    v_add_f32 v60, v60, v61
    v_mov_b32 v61, v60
    buffer_store_dwordx4 v[48:51], v1, s[4:7], s43 offen offset:1024 sc1 nt
    s_cmp_eq_u32 s49, 63
    v_permlane16_swap_b32 v61, v60
    v_add_f32 v60, v60, v61
    v_rcp_f32 v60, v60
    s_cbranch_scc1 rec_end
    v_pk_mul_f32 v[24:25], v[24:25], v[60:61] op_sel_hi:[1,0]
    v_pk_mul_f32 v[26:27], v[26:27], v[60:61] op_sel_hi:[1,0]
    v_pk_mul_f32 v[28:29], v[28:29], v[60:61] op_sel_hi:[1,0]
    v_pk_mul_f32 v[30:31], v[30:31], v[60:61] op_sel_hi:[1,0]
    v_cvt_pk_bf16_f32 v76, v24, v25
    v_cvt_pk_bf16_f32 v77, v26, v27
    v_cvt_pk_bf16_f32 v78, v28, v29
    v_cvt_pk_bf16_f32 v79, v30, v31
    ds_write_b128 v5, v[76:79]
    ds_read_b128 v[24:27], v3 offset:26624
    ds_read_b128 v[28:31], v3 offset:27648
    v_mov_b64 v[56:57], 0
    v_mov_b64 v[58:59], 0
    v_mov_b64 v[60:61], 0
    v_mov_b64 v[62:63], 0
    v_mov_b64 v[64:65], 0
    v_mov_b64 v[66:67], 0
    v_mov_b64 v[68:69], 0
    v_mov_b64 v[70:71], 0
    s_waitcnt lgkmcnt(2)
    s_barrier
    ds_read_b128 v[48:51], v1 offset:0
    ds_read_b128 v[52:55], v1 offset:1024
    v_mov_b64 v[72:73], 0
    v_mov_b64 v[74:75], 0
    v_mov_b64 v[76:77], 0
    v_mov_b64 v[78:79], 0
    s_waitcnt vmcnt(3)
    s_waitcnt lgkmcnt(1)
    v_smfmac_f32_16x16x64_bf16 v[56:59], v[48:51], v[8:15], v2
    s_add_u32 s42, s42, 16384
    v_smfmac_f32_16x16x64_bf16 v[60:63], v[48:51], v[16:23], v2
    s_waitcnt lgkmcnt(0)
    v_smfmac_f32_16x16x64_bf16 v[56:59], v[52:55], v[32:39], v2
    v_smfmac_f32_16x16x64_bf16 v[60:63], v[52:55], v[40:47], v2
    ds_read_b128 v[40:43], v3 offset:28672
    ds_read_b128 v[44:47], v3 offset:29696
    v_smfmac_f32_16x16x64_bf16 v[64:67], v[48:51], a[168:175], v2
    v_smfmac_f32_16x16x64_bf16 v[68:71], v[48:51], a[176:183], v2
    v_smfmac_f32_16x16x64_bf16 v[64:67], v[52:55], v[24:31], v2
    ds_read_b128 v[24:27], v3 offset:30720
    ds_read_b128 v[28:31], v3 offset:31744
    v_smfmac_f32_16x16x64_bf16 v[68:71], v[52:55], a[184:191], v2
    v_smfmac_f32_16x16x64_bf16 v[72:75], v[48:51], a[192:199], v2
    v_permlane32_swap_b32 v56, v60
    v_permlane32_swap_b32 v57, v61
    v_permlane32_swap_b32 v58, v62
    v_permlane32_swap_b32 v59, v63
    s_waitcnt lgkmcnt(2)
    v_smfmac_f32_16x16x64_bf16 v[76:79], v[48:51], v[40:47], v2
    ds_read_b128 v[40:43], v3 offset:32768
    ds_read_b128 v[44:47], v3 offset:33792
    v_pk_add_f32 v[56:57], v[56:57], v[60:61]
    v_pk_add_f32 v[58:59], v[58:59], v[62:63]
    v_cvt_pk_bf16_f32 v60, v56, v57
    v_cvt_pk_bf16_f32 v61, v58, v59
    v_smfmac_f32_16x16x64_bf16 v[72:75], v[52:55], a[200:207], v2
    v_and_or_b32 v60, v60, -2, s48
    buffer_store_dwordx2 v[60:61], v4, s[4:7], s55 offen sc1
    v_mov_b64 v[56:57], 0
    v_mov_b64 v[58:59], 0
    v_smfmac_f32_16x16x64_bf16 v[76:79], v[52:55], a[208:215], v2
    v_mov_b64 v[62:63], 0
    v_mov_b64 v[60:61], 0
    s_waitcnt lgkmcnt(2)
    v_smfmac_f32_16x16x64_bf16 v[56:59], v[48:51], v[24:31], v2
    ds_read_b128 v[24:27], v3 offset:34816
    ds_read_b128 v[28:31], v3 offset:35840
    v_permlane32_swap_b32 v64, v68
    v_permlane32_swap_b32 v65, v69
    v_permlane32_swap_b32 v66, v70
    v_permlane32_swap_b32 v67, v71
    v_smfmac_f32_16x16x64_bf16 v[60:63], v[48:51], a[216:223], v2
    v_pk_add_f32 v[64:65], v[64:65], v[68:69]
    v_pk_add_f32 v[66:67], v[66:67], v[70:71]
    v_cvt_pk_bf16_f32 v68, v64, v65
    v_cvt_pk_bf16_f32 v69, v66, v67
    v_smfmac_f32_16x16x64_bf16 v[56:59], v[52:55], a[224:231], v2
    v_and_or_b32 v68, v68, -2, s48
    buffer_store_dwordx2 v[68:69], v4, s[4:7], s56 offen sc1
    v_mov_b64 v[64:65], 0
    v_mov_b64 v[66:67], 0
    s_waitcnt lgkmcnt(2)
    v_smfmac_f32_16x16x64_bf16 v[60:63], v[52:55], v[40:47], v2
    v_mov_b64 v[70:71], 0
    v_mov_b64 v[68:69], 0
    v_smfmac_f32_16x16x64_bf16 v[64:67], v[48:51], a[232:239], v2
    v_permlane32_swap_b32 v72, v76
    v_permlane32_swap_b32 v73, v77
    v_permlane32_swap_b32 v74, v78
    v_smfmac_f32_16x16x64_bf16 v[68:71], v[48:51], a[240:247], v2
    v_permlane32_swap_b32 v75, v79
    v_pk_add_f32 v[72:73], v[72:73], v[76:77]
    v_pk_add_f32 v[74:75], v[74:75], v[78:79]
    s_waitcnt lgkmcnt(0)
    v_smfmac_f32_16x16x64_bf16 v[64:67], v[52:55], v[24:31], v2
    v_cvt_pk_bf16_f32 v76, v72, v73
    v_cvt_pk_bf16_f32 v77, v74, v75
    v_and_or_b32 v76, v76, -2, s48
    v_smfmac_f32_16x16x64_bf16 v[68:71], v[52:55], a[248:255], v2
    buffer_store_dwordx2 v[76:77], v4, s[4:7], s57 offen sc1
    v_permlane32_swap_b32 v56, v60
    v_permlane32_swap_b32 v57, v61
    v_permlane32_swap_b32 v58, v62
    v_permlane32_swap_b32 v59, v63
    v_pk_add_f32 v[56:57], v[56:57], v[60:61]
    v_pk_add_f32 v[58:59], v[58:59], v[62:63]
    v_cvt_pk_bf16_f32 v60, v56, v57
    v_cvt_pk_bf16_f32 v61, v58, v59
    v_and_or_b32 v60, v60, -2, s48
    buffer_store_dwordx2 v[60:61], v4, s[4:7], s58 offen sc1
    v_permlane32_swap_b32 v64, v68
    v_permlane32_swap_b32 v65, v69
    v_permlane32_swap_b32 v66, v70
    v_permlane32_swap_b32 v67, v71
    v_pk_add_f32 v[64:65], v[64:65], v[68:69]
    v_pk_add_f32 v[66:67], v[66:67], v[70:71]
    v_cvt_pk_bf16_f32 v68, v64, v65
    v_cvt_pk_bf16_f32 v69, v66, v67
    v_and_or_b32 v68, v68, -2, s48
    buffer_store_dwordx2 v[68:69], v4, s[4:7], s59 offen sc1
    s_add_u32 s12, s40, 5242880
    buffer_load_dwordx4 v[8:11], v1, s[4:7], s12 offen
    buffer_load_dwordx4 v[12:15], v1, s[4:7], s12 offen offset:1024
    s_add_u32 s12, s40, 5263360
    buffer_load_dwordx4 v[16:19], v1, s[4:7], s12 offen
    buffer_load_dwordx4 v[20:23], v1, s[4:7], s12 offen offset:1024
    s_cmp_eq_u32 s54, 0
    s_cbranch_scc1 recs_nored
    buffer_load_dwordx4 v[72:75], v1, s[4:7], s52 offen offset:1024
    v_bfe_u32 v52, v1, 9, 1
    v_and_b32 v53, 0xff, v4
    v_lshl_add_u32 v52, v52, 2, v53
recs_pr:
    s_sub_u32 s50, s50, 1
    s_cbranch_scc1 rec_end
    buffer_load_dwordx4 v[56:59], v1, s[4:7], s47 offen offset:0 sc1
    buffer_load_dwordx4 v[60:63], v1, s[4:7], s47 offen offset:1024 sc1
    buffer_load_dwordx4 v[64:67], v1, s[4:7], s47 offen offset:2048 sc1
    buffer_load_dwordx4 v[68:71], v1, s[4:7], s47 offen offset:3072 sc1
    s_waitcnt vmcnt(0)
    v_xor_b32 v7, s48, v56
    v_bitop3_b32 v7, v58, v7, s48 bitop3:0xde
    v_bitop3_b32 v7, v60, v7, s48 bitop3:0xde
    v_bitop3_b32 v7, v62, v7, s48 bitop3:0xde
    v_bitop3_b32 v7, v64, v7, s48 bitop3:0xde
    v_bitop3_b32 v7, v66, v7, s48 bitop3:0xde
    v_bitop3_b32 v7, v68, v7, s48 bitop3:0xde
    v_bitop3_b32 v7, v70, v7, s48 bitop3:0xde
    v_and_b32 v7, 1, v7
    v_cmp_ne_u32 vcc, 0, v7
    s_cbranch_vccnz recs_pr
    v_mfma_f32_16x16x32_bf16 v[76:79], v[56:59], v[72:75], 0
    v_mfma_f32_16x16x32_bf16 v[76:79], v[60:63], v[72:75], v[76:79]
    v_mfma_f32_16x16x32_bf16 v[76:79], v[64:67], v[72:75], v[76:79]
    v_mfma_f32_16x16x32_bf16 v[76:79], v[68:71], v[72:75], v[76:79]
    s_nop 7
    v_permlane32_swap_b32 v76, v78
    v_permlane32_swap_b32 v77, v79
    v_pk_add_f32 v[76:77], v[76:77], v[78:79]
    v_cvt_pk_bf16_f32 v76, v76, v77
    v_min_u32 v76, -2, v76
    buffer_store_dword v76, v52, s[4:7], s45 offen sc1
recs_nored:
    s_add_u32 s43, s43, 8192
    s_add_u32 s44, s44, 10240
    s_add_u32 s45, s45, 10240
    s_xor_b32 s48, s48, 1
    s_add_u32 s49, s49, 1
    s_barrier
    s_add_u32 s12, s40, 20480
    buffer_load_dwordx4 v[40:43], v1, s[4:7], s12 offen
    buffer_load_dwordx4 v[44:47], v1, s[4:7], s12 offen offset:1024
    s_add_u32 s12, s40, 0
    buffer_load_dwordx4 v[24:27], v1, s[4:7], s12 offen
    buffer_load_dwordx4 v[28:31], v1, s[4:7], s12 offen offset:1024
    s_branch recs_loop
rec_end:
    s_waitcnt vmcnt(0)
    v_mov_b32 v0, 0x100
    buffer_store_dword v0, off, s[4:7], s82 sc1
rec_exit:
    s_endpgm
rec_work:
    s_sub_u32 s40, s40, 1
    s_mov_b32 s41, s14
    v_lshlrev_b32 v1, 4, v1
    s_lshl_b32 s13, s40, 5
    s_add_u32 s13, s13, s41
    s_cmp_ge_u32 s13, 128
    s_cbranch_scc1 g1_q
    s_lshr_b32 s12, s13, 2
    s_and_b32 s22, s13, 3
    s_mov_b32 s23, 4
    s_lshl_b32 s33, s12, 2
    s_add_u32 s33, s33, s3
    s_lshl_b32 s33, s33, 2
    s_add_u32 s33, s33, s22
    s_lshl_b32 s33, s33, 2
    s_add_u32 s33, s33, 47120384
    s_lshl_b32 s24, s12, 2
    s_add_u32 s24, s24, s3
    s_mul_i32 s20, s24, 40960
    s_add_u32 s21, s20, 10485760
    s_add_u32 s20, s20, 5242880
    s_mul_i32 s24, s12, 260
    s_add_u32 s24, s24, s3
    s_lshl_b32 s24, s24, 12
    s_add_u32 s24, s24, 167772160
    s_mov_b32 s25, 16384
    buffer_load_dwordx4 v[192:195], v1, s[4:7], s20 offen offset:0
    buffer_load_dwordx4 v[196:199], v1, s[4:7], s20 offen offset:1024
    buffer_load_dwordx4 v[200:203], v1, s[4:7], s20 offen offset:2048
    buffer_load_dwordx4 v[204:207], v1, s[4:7], s20 offen offset:3072
    s_add_u32 s20, s20, 4096
    buffer_load_dwordx4 v[208:211], v1, s[4:7], s20 offen offset:0
    buffer_load_dwordx4 v[212:215], v1, s[4:7], s20 offen offset:1024
    buffer_load_dwordx4 v[216:219], v1, s[4:7], s20 offen offset:2048
    buffer_load_dwordx4 v[220:223], v1, s[4:7], s20 offen offset:3072
    s_add_u32 s20, s20, 4096
    buffer_load_dwordx4 v[224:227], v1, s[4:7], s20 offen offset:0
    buffer_load_dwordx4 v[228:231], v1, s[4:7], s20 offen offset:1024
    buffer_load_dwordx4 v[232:235], v1, s[4:7], s20 offen offset:2048
    buffer_load_dwordx4 v[236:239], v1, s[4:7], s20 offen offset:3072
    s_add_u32 s20, s20, 4096
    buffer_load_dwordx4 v[240:243], v1, s[4:7], s20 offen offset:0
    buffer_load_dwordx4 v[244:247], v1, s[4:7], s20 offen offset:1024
    buffer_load_dwordx4 v[248:251], v1, s[4:7], s20 offen offset:2048
    buffer_load_dwordx4 v[252:255], v1, s[4:7], s20 offen offset:3072
    s_add_u32 s20, s20, 4096
    buffer_load_dwordx4 a[0:3], v1, s[4:7], s20 offen offset:0
    buffer_load_dwordx4 a[4:7], v1, s[4:7], s20 offen offset:1024
    buffer_load_dwordx4 a[8:11], v1, s[4:7], s20 offen offset:2048
    buffer_load_dwordx4 a[12:15], v1, s[4:7], s20 offen offset:3072
    s_add_u32 s20, s20, 4096
    buffer_load_dwordx4 a[16:19], v1, s[4:7], s20 offen offset:0
    buffer_load_dwordx4 a[20:23], v1, s[4:7], s20 offen offset:1024
    buffer_load_dwordx4 a[24:27], v1, s[4:7], s20 offen offset:2048
    buffer_load_dwordx4 a[28:31], v1, s[4:7], s20 offen offset:3072
    s_add_u32 s20, s20, 4096
    buffer_load_dwordx4 a[32:35], v1, s[4:7], s20 offen offset:0
    buffer_load_dwordx4 a[36:39], v1, s[4:7], s20 offen offset:1024
    buffer_load_dwordx4 a[40:43], v1, s[4:7], s20 offen offset:2048
    buffer_load_dwordx4 a[44:47], v1, s[4:7], s20 offen offset:3072
    s_add_u32 s20, s20, 4096
    buffer_load_dwordx4 a[48:51], v1, s[4:7], s20 offen offset:0
    buffer_load_dwordx4 a[52:55], v1, s[4:7], s20 offen offset:1024
    buffer_load_dwordx4 a[56:59], v1, s[4:7], s20 offen offset:2048
    buffer_load_dwordx4 a[60:63], v1, s[4:7], s20 offen offset:3072
    s_add_u32 s20, s20, 4096
    buffer_load_dwordx4 a[64:67], v1, s[4:7], s20 offen offset:0
    buffer_load_dwordx4 a[68:71], v1, s[4:7], s20 offen offset:1024
    buffer_load_dwordx4 a[72:75], v1, s[4:7], s20 offen offset:2048
    buffer_load_dwordx4 a[76:79], v1, s[4:7], s20 offen offset:3072
    s_add_u32 s20, s20, 4096
    buffer_load_dwordx4 a[80:83], v1, s[4:7], s20 offen offset:0
    buffer_load_dwordx4 a[84:87], v1, s[4:7], s20 offen offset:1024
    buffer_load_dwordx4 a[88:91], v1, s[4:7], s20 offen offset:2048
    buffer_load_dwordx4 a[92:95], v1, s[4:7], s20 offen offset:3072
    s_add_u32 s20, s20, 4096
    buffer_load_dwordx4 a[96:99], v1, s[4:7], s21 offen offset:0
    buffer_load_dwordx4 a[100:103], v1, s[4:7], s21 offen offset:1024
    buffer_load_dwordx4 a[104:107], v1, s[4:7], s21 offen offset:2048
    buffer_load_dwordx4 a[108:111], v1, s[4:7], s21 offen offset:3072
    s_add_u32 s21, s21, 4096
    buffer_load_dwordx4 a[112:115], v1, s[4:7], s21 offen offset:0
    buffer_load_dwordx4 a[116:119], v1, s[4:7], s21 offen offset:1024
    buffer_load_dwordx4 a[120:123], v1, s[4:7], s21 offen offset:2048
    buffer_load_dwordx4 a[124:127], v1, s[4:7], s21 offen offset:3072
    s_add_u32 s21, s21, 4096
    buffer_load_dwordx4 a[128:131], v1, s[4:7], s21 offen offset:0
    buffer_load_dwordx4 a[132:135], v1, s[4:7], s21 offen offset:1024
    buffer_load_dwordx4 a[136:139], v1, s[4:7], s21 offen offset:2048
    buffer_load_dwordx4 a[140:143], v1, s[4:7], s21 offen offset:3072
    s_add_u32 s21, s21, 4096
    buffer_load_dwordx4 a[144:147], v1, s[4:7], s21 offen offset:0
    buffer_load_dwordx4 a[148:151], v1, s[4:7], s21 offen offset:1024
    buffer_load_dwordx4 a[152:155], v1, s[4:7], s21 offen offset:2048
    buffer_load_dwordx4 a[156:159], v1, s[4:7], s21 offen offset:3072
    s_add_u32 s21, s21, 4096
    buffer_load_dwordx4 a[160:163], v1, s[4:7], s21 offen offset:0
    buffer_load_dwordx4 a[164:167], v1, s[4:7], s21 offen offset:1024
    buffer_load_dwordx4 a[168:171], v1, s[4:7], s21 offen offset:2048
    buffer_load_dwordx4 a[172:175], v1, s[4:7], s21 offen offset:3072
    s_add_u32 s21, s21, 4096
    buffer_load_dwordx4 a[176:179], v1, s[4:7], s21 offen offset:0
    buffer_load_dwordx4 a[180:183], v1, s[4:7], s21 offen offset:1024
    buffer_load_dwordx4 a[184:187], v1, s[4:7], s21 offen offset:2048
    buffer_load_dwordx4 a[188:191], v1, s[4:7], s21 offen offset:3072
    s_add_u32 s21, s21, 4096
    buffer_load_dwordx4 a[192:195], v1, s[4:7], s21 offen offset:0
    buffer_load_dwordx4 a[196:199], v1, s[4:7], s21 offen offset:1024
    buffer_load_dwordx4 a[200:203], v1, s[4:7], s21 offen offset:2048
    buffer_load_dwordx4 a[204:207], v1, s[4:7], s21 offen offset:3072
    s_add_u32 s21, s21, 4096
    buffer_load_dwordx4 a[208:211], v1, s[4:7], s21 offen offset:0
    buffer_load_dwordx4 a[212:215], v1, s[4:7], s21 offen offset:1024
    buffer_load_dwordx4 a[216:219], v1, s[4:7], s21 offen offset:2048
    buffer_load_dwordx4 a[220:223], v1, s[4:7], s21 offen offset:3072
    s_add_u32 s21, s21, 4096
    buffer_load_dwordx4 a[224:227], v1, s[4:7], s21 offen offset:0
    buffer_load_dwordx4 a[228:231], v1, s[4:7], s21 offen offset:1024
    buffer_load_dwordx4 a[232:235], v1, s[4:7], s21 offen offset:2048
    buffer_load_dwordx4 a[236:239], v1, s[4:7], s21 offen offset:3072
    s_add_u32 s21, s21, 4096
    buffer_load_dwordx4 a[240:243], v1, s[4:7], s21 offen offset:0
    buffer_load_dwordx4 a[244:247], v1, s[4:7], s21 offen offset:1024
    buffer_load_dwordx4 a[248:251], v1, s[4:7], s21 offen offset:2048
    buffer_load_dwordx4 a[252:255], v1, s[4:7], s21 offen offset:3072
    s_add_u32 s21, s21, 4096
    s_mov_b32 s26, 0
    s_mul_i32 s27, s22, 40960
    s_mul_i32 s28, s3, 10240
    s_add_u32 s27, s27, s28
    s_add_u32 s27, s27, 35651584
    s_add_u32 s28, s28, s26
    s_mov_b32 m0, s28
    s_add_u32 s28, s28, 4096
    buffer_load_dwordx4 v1, s[4:7], s27 offen offset:0 lds
    buffer_load_dwordx4 v1, s[4:7], s27 offen offset:1024 lds
    buffer_load_dwordx4 v1, s[4:7], s27 offen offset:2048 lds
    buffer_load_dwordx4 v1, s[4:7], s27 offen offset:3072 lds
    s_add_u32 s27, s27, 4096
    s_mov_b32 m0, s28
    s_add_u32 s28, s28, 4096
    buffer_load_dwordx4 v1, s[4:7], s27 offen offset:0 lds
    buffer_load_dwordx4 v1, s[4:7], s27 offen offset:1024 lds
    buffer_load_dwordx4 v1, s[4:7], s27 offen offset:2048 lds
    buffer_load_dwordx4 v1, s[4:7], s27 offen offset:3072 lds
    s_add_u32 s27, s27, 4096
    s_mov_b32 m0, s28
    s_add_u32 s28, s28, 4096
    buffer_load_dwordx4 v1, s[4:7], s27 offen offset:0 lds
    buffer_load_dwordx4 v1, s[4:7], s27 offen offset:1024 lds
    s_waitcnt vmcnt(0)
g1kv_loop:
    s_waitcnt vmcnt(4)
    s_barrier
    v_add_u32 v2, s26, v1
    s_xor_b32 s26, s26, 40960
    s_add_u32 s29, s22, s23
    s_cmp_ge_u32 s29, 64
    s_cbranch_scc1 g1kv_nodma
    s_mul_i32 s27, s29, 40960
    s_mul_i32 s28, s3, 10240
    s_add_u32 s27, s27, s28
    s_add_u32 s27, s27, 35651584
    s_add_u32 s28, s28, s26
    s_mov_b32 m0, s28
    s_add_u32 s28, s28, 4096
    buffer_load_dwordx4 v1, s[4:7], s27 offen offset:0 lds
    buffer_load_dwordx4 v1, s[4:7], s27 offen offset:1024 lds
    buffer_load_dwordx4 v1, s[4:7], s27 offen offset:2048 lds
    buffer_load_dwordx4 v1, s[4:7], s27 offen offset:3072 lds
    s_add_u32 s27, s27, 4096
    s_mov_b32 m0, s28
    s_add_u32 s28, s28, 4096
    buffer_load_dwordx4 v1, s[4:7], s27 offen offset:0 lds
    buffer_load_dwordx4 v1, s[4:7], s27 offen offset:1024 lds
    buffer_load_dwordx4 v1, s[4:7], s27 offen offset:2048 lds
    buffer_load_dwordx4 v1, s[4:7], s27 offen offset:3072 lds
    s_add_u32 s27, s27, 4096
    s_mov_b32 m0, s28
    s_add_u32 s28, s28, 4096
    buffer_load_dwordx4 v1, s[4:7], s27 offen offset:0 lds
    buffer_load_dwordx4 v1, s[4:7], s27 offen offset:1024 lds
g1kv_nodma:
    ds_read_b128 v[48:51], v2 offset:0
    ds_read_b128 v[52:55], v2 offset:20480
    ds_read_b128 v[56:59], v2 offset:1024
    ds_read_b128 v[60:63], v2 offset:21504
    s_waitcnt lgkmcnt(2)
    v_mfma_f32_16x16x32_bf16 v[16:19], v[192:195], v[48:51], 0
    v_mfma_f32_16x16x32_bf16 v[20:23], v[192:195], v[52:55], 0
    v_mfma_f32_16x16x32_bf16 v[24:27], a[16:19], v[48:51], 0
    v_mfma_f32_16x16x32_bf16 v[28:31], a[16:19], v[52:55], 0
    v_mfma_f32_16x16x32_bf16 v[32:35], v[48:51], a[96:99], 0
    v_mfma_f32_16x16x32_bf16 v[36:39], v[52:55], a[96:99], 0
    v_mfma_f32_16x16x32_bf16 v[40:43], v[48:51], a[176:179], 0
    v_mfma_f32_16x16x32_bf16 v[44:47], v[52:55], a[176:179], 0
    ds_read_b128 v[48:51], v2 offset:2048
    ds_read_b128 v[52:55], v2 offset:22528
    s_waitcnt lgkmcnt(2)
    v_mfma_f32_16x16x32_bf16 v[16:19], v[196:199], v[56:59], v[16:19]
    v_mfma_f32_16x16x32_bf16 v[20:23], v[196:199], v[60:63], v[20:23]
    v_mfma_f32_16x16x32_bf16 v[24:27], a[20:23], v[56:59], v[24:27]
    v_mfma_f32_16x16x32_bf16 v[28:31], a[20:23], v[60:63], v[28:31]
    v_mfma_f32_16x16x32_bf16 v[32:35], v[56:59], a[100:103], v[32:35]
    v_mfma_f32_16x16x32_bf16 v[36:39], v[60:63], a[100:103], v[36:39]
    v_mfma_f32_16x16x32_bf16 v[40:43], v[56:59], a[180:183], v[40:43]
    v_mfma_f32_16x16x32_bf16 v[44:47], v[60:63], a[180:183], v[44:47]
    ds_read_b128 v[56:59], v2 offset:3072
    ds_read_b128 v[60:63], v2 offset:23552
    s_waitcnt lgkmcnt(2)
    v_mfma_f32_16x16x32_bf16 v[16:19], v[200:203], v[48:51], v[16:19]
    v_mfma_f32_16x16x32_bf16 v[20:23], v[200:203], v[52:55], v[20:23]
    v_mfma_f32_16x16x32_bf16 v[24:27], a[24:27], v[48:51], v[24:27]
    v_mfma_f32_16x16x32_bf16 v[28:31], a[24:27], v[52:55], v[28:31]
    v_mfma_f32_16x16x32_bf16 v[32:35], v[48:51], a[104:107], v[32:35]
    v_mfma_f32_16x16x32_bf16 v[36:39], v[52:55], a[104:107], v[36:39]
    v_mfma_f32_16x16x32_bf16 v[40:43], v[48:51], a[184:187], v[40:43]
    v_mfma_f32_16x16x32_bf16 v[44:47], v[52:55], a[184:187], v[44:47]
    ds_read_b128 v[48:51], v2 offset:4096
    ds_read_b128 v[52:55], v2 offset:24576
    s_waitcnt lgkmcnt(2)
    v_mfma_f32_16x16x32_bf16 v[16:19], v[204:207], v[56:59], v[16:19]
    v_mfma_f32_16x16x32_bf16 v[20:23], v[204:207], v[60:63], v[20:23]
    v_mfma_f32_16x16x32_bf16 v[24:27], a[28:31], v[56:59], v[24:27]
    v_mfma_f32_16x16x32_bf16 v[28:31], a[28:31], v[60:63], v[28:31]
    v_mfma_f32_16x16x32_bf16 v[32:35], v[56:59], a[108:111], v[32:35]
    v_mfma_f32_16x16x32_bf16 v[36:39], v[60:63], a[108:111], v[36:39]
    v_mfma_f32_16x16x32_bf16 v[40:43], v[56:59], a[188:191], v[40:43]
    v_mfma_f32_16x16x32_bf16 v[44:47], v[60:63], a[188:191], v[44:47]
    ds_read_b128 v[56:59], v2 offset:5120
    ds_read_b128 v[60:63], v2 offset:25600
    s_waitcnt lgkmcnt(2)
    v_mfma_f32_16x16x32_bf16 v[16:19], v[208:211], v[48:51], v[16:19]
    v_mfma_f32_16x16x32_bf16 v[20:23], v[208:211], v[52:55], v[20:23]
    v_mfma_f32_16x16x32_bf16 v[24:27], a[32:35], v[48:51], v[24:27]
    v_mfma_f32_16x16x32_bf16 v[28:31], a[32:35], v[52:55], v[28:31]
    v_mfma_f32_16x16x32_bf16 v[32:35], v[48:51], a[112:115], v[32:35]
    v_mfma_f32_16x16x32_bf16 v[36:39], v[52:55], a[112:115], v[36:39]
    v_mfma_f32_16x16x32_bf16 v[40:43], v[48:51], a[192:195], v[40:43]
    v_mfma_f32_16x16x32_bf16 v[44:47], v[52:55], a[192:195], v[44:47]
    ds_read_b128 v[48:51], v2 offset:6144
    ds_read_b128 v[52:55], v2 offset:26624
    s_waitcnt lgkmcnt(2)
    v_mfma_f32_16x16x32_bf16 v[16:19], v[212:215], v[56:59], v[16:19]
    v_mfma_f32_16x16x32_bf16 v[20:23], v[212:215], v[60:63], v[20:23]
    v_mfma_f32_16x16x32_bf16 v[24:27], a[36:39], v[56:59], v[24:27]
    v_mfma_f32_16x16x32_bf16 v[28:31], a[36:39], v[60:63], v[28:31]
    v_mfma_f32_16x16x32_bf16 v[32:35], v[56:59], a[116:119], v[32:35]
    v_mfma_f32_16x16x32_bf16 v[36:39], v[60:63], a[116:119], v[36:39]
    v_mfma_f32_16x16x32_bf16 v[40:43], v[56:59], a[196:199], v[40:43]
    v_mfma_f32_16x16x32_bf16 v[44:47], v[60:63], a[196:199], v[44:47]
    ds_read_b128 v[56:59], v2 offset:7168
    ds_read_b128 v[60:63], v2 offset:27648
    s_waitcnt lgkmcnt(2)
    v_mfma_f32_16x16x32_bf16 v[16:19], v[216:219], v[48:51], v[16:19]
    v_mfma_f32_16x16x32_bf16 v[20:23], v[216:219], v[52:55], v[20:23]
    v_mfma_f32_16x16x32_bf16 v[24:27], a[40:43], v[48:51], v[24:27]
    v_mfma_f32_16x16x32_bf16 v[28:31], a[40:43], v[52:55], v[28:31]
    v_mfma_f32_16x16x32_bf16 v[32:35], v[48:51], a[120:123], v[32:35]
    v_mfma_f32_16x16x32_bf16 v[36:39], v[52:55], a[120:123], v[36:39]
    v_mfma_f32_16x16x32_bf16 v[40:43], v[48:51], a[200:203], v[40:43]
    v_mfma_f32_16x16x32_bf16 v[44:47], v[52:55], a[200:203], v[44:47]
    ds_read_b128 v[48:51], v2 offset:8192
    ds_read_b128 v[52:55], v2 offset:28672
    s_waitcnt lgkmcnt(2)
    v_mfma_f32_16x16x32_bf16 v[16:19], v[220:223], v[56:59], v[16:19]
    v_mfma_f32_16x16x32_bf16 v[20:23], v[220:223], v[60:63], v[20:23]
    v_mfma_f32_16x16x32_bf16 v[24:27], a[44:47], v[56:59], v[24:27]
    v_mfma_f32_16x16x32_bf16 v[28:31], a[44:47], v[60:63], v[28:31]
    v_mfma_f32_16x16x32_bf16 v[32:35], v[56:59], a[124:127], v[32:35]
    v_mfma_f32_16x16x32_bf16 v[36:39], v[60:63], a[124:127], v[36:39]
    v_mfma_f32_16x16x32_bf16 v[40:43], v[56:59], a[204:207], v[40:43]
    v_mfma_f32_16x16x32_bf16 v[44:47], v[60:63], a[204:207], v[44:47]
    ds_read_b128 v[56:59], v2 offset:9216
    ds_read_b128 v[60:63], v2 offset:29696
    s_waitcnt lgkmcnt(2)
    v_mfma_f32_16x16x32_bf16 v[16:19], v[224:227], v[48:51], v[16:19]
    v_mfma_f32_16x16x32_bf16 v[20:23], v[224:227], v[52:55], v[20:23]
    v_mfma_f32_16x16x32_bf16 v[24:27], a[48:51], v[48:51], v[24:27]
    v_mfma_f32_16x16x32_bf16 v[28:31], a[48:51], v[52:55], v[28:31]
    v_mfma_f32_16x16x32_bf16 v[32:35], v[48:51], a[128:131], v[32:35]
    v_mfma_f32_16x16x32_bf16 v[36:39], v[52:55], a[128:131], v[36:39]
    v_mfma_f32_16x16x32_bf16 v[40:43], v[48:51], a[208:211], v[40:43]
    v_mfma_f32_16x16x32_bf16 v[44:47], v[52:55], a[208:211], v[44:47]
    ds_read_b128 v[48:51], v2 offset:10240
    ds_read_b128 v[52:55], v2 offset:30720
    s_waitcnt lgkmcnt(2)
    v_mfma_f32_16x16x32_bf16 v[16:19], v[228:231], v[56:59], v[16:19]
    v_mfma_f32_16x16x32_bf16 v[20:23], v[228:231], v[60:63], v[20:23]
    v_mfma_f32_16x16x32_bf16 v[24:27], a[52:55], v[56:59], v[24:27]
    v_mfma_f32_16x16x32_bf16 v[28:31], a[52:55], v[60:63], v[28:31]
    v_mfma_f32_16x16x32_bf16 v[32:35], v[56:59], a[132:135], v[32:35]
    v_mfma_f32_16x16x32_bf16 v[36:39], v[60:63], a[132:135], v[36:39]
    v_mfma_f32_16x16x32_bf16 v[40:43], v[56:59], a[212:215], v[40:43]
    v_mfma_f32_16x16x32_bf16 v[44:47], v[60:63], a[212:215], v[44:47]
    ds_read_b128 v[56:59], v2 offset:11264
    ds_read_b128 v[60:63], v2 offset:31744
    s_waitcnt lgkmcnt(2)
    v_mfma_f32_16x16x32_bf16 v[16:19], v[232:235], v[48:51], v[16:19]
    v_mfma_f32_16x16x32_bf16 v[20:23], v[232:235], v[52:55], v[20:23]
    v_mfma_f32_16x16x32_bf16 v[24:27], a[56:59], v[48:51], v[24:27]
    v_mfma_f32_16x16x32_bf16 v[28:31], a[56:59], v[52:55], v[28:31]
    v_mfma_f32_16x16x32_bf16 v[32:35], v[48:51], a[136:139], v[32:35]
    v_mfma_f32_16x16x32_bf16 v[36:39], v[52:55], a[136:139], v[36:39]
    v_mfma_f32_16x16x32_bf16 v[40:43], v[48:51], a[216:219], v[40:43]
    v_mfma_f32_16x16x32_bf16 v[44:47], v[52:55], a[216:219], v[44:47]
    ds_read_b128 v[48:51], v2 offset:12288
    ds_read_b128 v[52:55], v2 offset:32768
    s_waitcnt lgkmcnt(2)
    v_mfma_f32_16x16x32_bf16 v[16:19], v[236:239], v[56:59], v[16:19]
    v_mfma_f32_16x16x32_bf16 v[20:23], v[236:239], v[60:63], v[20:23]
    v_mfma_f32_16x16x32_bf16 v[24:27], a[60:63], v[56:59], v[24:27]
    v_mfma_f32_16x16x32_bf16 v[28:31], a[60:63], v[60:63], v[28:31]
    v_mfma_f32_16x16x32_bf16 v[32:35], v[56:59], a[140:143], v[32:35]
    v_mfma_f32_16x16x32_bf16 v[36:39], v[60:63], a[140:143], v[36:39]
    v_mfma_f32_16x16x32_bf16 v[40:43], v[56:59], a[220:223], v[40:43]
    v_mfma_f32_16x16x32_bf16 v[44:47], v[60:63], a[220:223], v[44:47]
    ds_read_b128 v[56:59], v2 offset:13312
    ds_read_b128 v[60:63], v2 offset:33792
    s_waitcnt lgkmcnt(2)
    v_mfma_f32_16x16x32_bf16 v[16:19], v[240:243], v[48:51], v[16:19]
    v_mfma_f32_16x16x32_bf16 v[20:23], v[240:243], v[52:55], v[20:23]
    v_mfma_f32_16x16x32_bf16 v[24:27], a[64:67], v[48:51], v[24:27]
    v_mfma_f32_16x16x32_bf16 v[28:31], a[64:67], v[52:55], v[28:31]
    v_mfma_f32_16x16x32_bf16 v[32:35], v[48:51], a[144:147], v[32:35]
    v_mfma_f32_16x16x32_bf16 v[36:39], v[52:55], a[144:147], v[36:39]
    v_mfma_f32_16x16x32_bf16 v[40:43], v[48:51], a[224:227], v[40:43]
    v_mfma_f32_16x16x32_bf16 v[44:47], v[52:55], a[224:227], v[44:47]
    ds_read_b128 v[48:51], v2 offset:14336
    ds_read_b128 v[52:55], v2 offset:34816
    s_waitcnt lgkmcnt(2)
    v_mfma_f32_16x16x32_bf16 v[16:19], v[244:247], v[56:59], v[16:19]
    v_mfma_f32_16x16x32_bf16 v[20:23], v[244:247], v[60:63], v[20:23]
    v_mfma_f32_16x16x32_bf16 v[24:27], a[68:71], v[56:59], v[24:27]
    v_mfma_f32_16x16x32_bf16 v[28:31], a[68:71], v[60:63], v[28:31]
    v_mfma_f32_16x16x32_bf16 v[32:35], v[56:59], a[148:151], v[32:35]
    v_mfma_f32_16x16x32_bf16 v[36:39], v[60:63], a[148:151], v[36:39]
    v_mfma_f32_16x16x32_bf16 v[40:43], v[56:59], a[228:231], v[40:43]
    v_mfma_f32_16x16x32_bf16 v[44:47], v[60:63], a[228:231], v[44:47]
    ds_read_b128 v[56:59], v2 offset:15360
    ds_read_b128 v[60:63], v2 offset:35840
    s_waitcnt lgkmcnt(2)
    v_mfma_f32_16x16x32_bf16 v[16:19], v[248:251], v[48:51], v[16:19]
    v_mfma_f32_16x16x32_bf16 v[20:23], v[248:251], v[52:55], v[20:23]
    v_mfma_f32_16x16x32_bf16 v[24:27], a[72:75], v[48:51], v[24:27]
    v_mfma_f32_16x16x32_bf16 v[28:31], a[72:75], v[52:55], v[28:31]
    v_mfma_f32_16x16x32_bf16 v[32:35], v[48:51], a[152:155], v[32:35]
    v_mfma_f32_16x16x32_bf16 v[36:39], v[52:55], a[152:155], v[36:39]
    v_mfma_f32_16x16x32_bf16 v[40:43], v[48:51], a[232:235], v[40:43]
    v_mfma_f32_16x16x32_bf16 v[44:47], v[52:55], a[232:235], v[44:47]
    ds_read_b128 v[48:51], v2 offset:16384
    ds_read_b128 v[52:55], v2 offset:36864
    s_waitcnt lgkmcnt(2)
    v_mfma_f32_16x16x32_bf16 v[16:19], v[252:255], v[56:59], v[16:19]
    v_mfma_f32_16x16x32_bf16 v[20:23], v[252:255], v[60:63], v[20:23]
    v_mfma_f32_16x16x32_bf16 v[24:27], a[76:79], v[56:59], v[24:27]
    v_mfma_f32_16x16x32_bf16 v[28:31], a[76:79], v[60:63], v[28:31]
    v_mfma_f32_16x16x32_bf16 v[32:35], v[56:59], a[156:159], v[32:35]
    v_mfma_f32_16x16x32_bf16 v[36:39], v[60:63], a[156:159], v[36:39]
    v_mfma_f32_16x16x32_bf16 v[40:43], v[56:59], a[236:239], v[40:43]
    v_mfma_f32_16x16x32_bf16 v[44:47], v[60:63], a[236:239], v[44:47]
    ds_read_b128 v[56:59], v2 offset:17408
    ds_read_b128 v[60:63], v2 offset:37888
    s_waitcnt lgkmcnt(2)
    v_mfma_f32_16x16x32_bf16 v[16:19], a[0:3], v[48:51], v[16:19]
    v_mfma_f32_16x16x32_bf16 v[20:23], a[0:3], v[52:55], v[20:23]
    v_mfma_f32_16x16x32_bf16 v[24:27], a[80:83], v[48:51], v[24:27]
    v_mfma_f32_16x16x32_bf16 v[28:31], a[80:83], v[52:55], v[28:31]
    v_mfma_f32_16x16x32_bf16 v[32:35], v[48:51], a[160:163], v[32:35]
    v_mfma_f32_16x16x32_bf16 v[36:39], v[52:55], a[160:163], v[36:39]
    v_mfma_f32_16x16x32_bf16 v[40:43], v[48:51], a[240:243], v[40:43]
    v_mfma_f32_16x16x32_bf16 v[44:47], v[52:55], a[240:243], v[44:47]
    ds_read_b128 v[48:51], v2 offset:18432
    ds_read_b128 v[52:55], v2 offset:38912
    s_waitcnt lgkmcnt(2)
    v_mfma_f32_16x16x32_bf16 v[16:19], a[4:7], v[56:59], v[16:19]
    v_mfma_f32_16x16x32_bf16 v[20:23], a[4:7], v[60:63], v[20:23]
    v_mfma_f32_16x16x32_bf16 v[24:27], a[84:87], v[56:59], v[24:27]
    v_mfma_f32_16x16x32_bf16 v[28:31], a[84:87], v[60:63], v[28:31]
    v_mfma_f32_16x16x32_bf16 v[32:35], v[56:59], a[164:167], v[32:35]
    v_mfma_f32_16x16x32_bf16 v[36:39], v[60:63], a[164:167], v[36:39]
    v_mfma_f32_16x16x32_bf16 v[40:43], v[56:59], a[244:247], v[40:43]
    v_mfma_f32_16x16x32_bf16 v[44:47], v[60:63], a[244:247], v[44:47]
    ds_read_b128 v[56:59], v2 offset:19456
    ds_read_b128 v[60:63], v2 offset:39936
    s_waitcnt lgkmcnt(2)
    v_mfma_f32_16x16x32_bf16 v[16:19], a[8:11], v[48:51], v[16:19]
    v_mfma_f32_16x16x32_bf16 v[20:23], a[8:11], v[52:55], v[20:23]
    v_mfma_f32_16x16x32_bf16 v[24:27], a[88:91], v[48:51], v[24:27]
    v_mfma_f32_16x16x32_bf16 v[28:31], a[88:91], v[52:55], v[28:31]
    v_mfma_f32_16x16x32_bf16 v[32:35], v[48:51], a[168:171], v[32:35]
    v_mfma_f32_16x16x32_bf16 v[36:39], v[52:55], a[168:171], v[36:39]
    v_mfma_f32_16x16x32_bf16 v[40:43], v[48:51], a[248:251], v[40:43]
    v_mfma_f32_16x16x32_bf16 v[44:47], v[52:55], a[248:251], v[44:47]
    s_waitcnt lgkmcnt(0)
    v_mfma_f32_16x16x32_bf16 v[16:19], a[12:15], v[56:59], v[16:19]
    v_mfma_f32_16x16x32_bf16 v[20:23], a[12:15], v[60:63], v[20:23]
    v_mfma_f32_16x16x32_bf16 v[24:27], a[92:95], v[56:59], v[24:27]
    v_mfma_f32_16x16x32_bf16 v[28:31], a[92:95], v[60:63], v[28:31]
    v_mfma_f32_16x16x32_bf16 v[32:35], v[56:59], a[172:175], v[32:35]
    v_mfma_f32_16x16x32_bf16 v[36:39], v[60:63], a[172:175], v[36:39]
    v_mfma_f32_16x16x32_bf16 v[40:43], v[56:59], a[252:255], v[40:43]
    v_mfma_f32_16x16x32_bf16 v[44:47], v[60:63], a[252:255], v[44:47]
    s_mul_i32 s27, s22, s25
    s_add_u32 s27, s27, s24
    s_nop 6
    s_waitcnt vmcnt(0)
    v_mov_b32 v3, s22
    buffer_store_dword v3, off, s[4:7], s33 sc1
    v_cvt_pk_bf16_f32 v64, v16, v17
    v_cvt_pk_bf16_f32 v65, v18, v19
    v_cvt_pk_bf16_f32 v66, v24, v25
    v_cvt_pk_bf16_f32 v67, v26, v27
    buffer_store_dwordx4 v[64:67], v1, s[4:7], s27 offen offset:0 sc1
    v_cvt_pk_bf16_f32 v68, v20, v21
    v_cvt_pk_bf16_f32 v69, v22, v23
    v_cvt_pk_bf16_f32 v70, v28, v29
    v_cvt_pk_bf16_f32 v71, v30, v31
    buffer_store_dwordx4 v[68:71], v1, s[4:7], s27 offen offset:1024 sc1
    v_cvt_pk_bf16_f32 v72, v32, v33
    v_cvt_pk_bf16_f32 v73, v34, v35
    v_cvt_pk_bf16_f32 v74, v36, v37
    v_cvt_pk_bf16_f32 v75, v38, v39
    buffer_store_dwordx4 v[72:75], v1, s[4:7], s27 offen offset:2048 sc1
    v_cvt_pk_bf16_f32 v76, v40, v41
    v_cvt_pk_bf16_f32 v77, v42, v43
    v_cvt_pk_bf16_f32 v78, v44, v45
    v_cvt_pk_bf16_f32 v79, v46, v47
    buffer_store_dwordx4 v[76:79], v1, s[4:7], s27 offen offset:3072 sc1
    s_mov_b32 s22, s29
    s_cmp_lt_u32 s22, 64
    s_cbranch_scc1 g1kv_loop
    s_waitcnt vmcnt(0)
    v_mov_b32 v3, 0x100
    buffer_store_dword v3, off, s[4:7], s33 sc1
    s_lshl_b32 s34, s40, 5
    s_add_u32 s34, s34, s41
    v_lshrrev_b32 v1, 4, v1
    s_barrier
g1_late:
    s_mov_b32 s2, s34
    s_cmp_ge_u32 s2, 320
    s_cbranch_scc1 late_m0
    s_load_dwordx2 s[8:9], s[0:1], 40
    s_mov_b32 s10, 5242880
    s_mov_b32 s11, 0x00020000
    s_mov_b32 s12, 1280
    s_mov_b32 s13, 10
    s_mov_b32 s14, 429496730
    s_mov_b32 s15, 131072
    s_mov_b32 s16, 27262976
    s_mov_b32 s24, 1024
    s_mov_b32 s25, 512
    s_mov_b32 s26, 256
    s_mov_b32 s27, 128
    s_mov_b32 s28, 2048
    s_branch late_go
late_m0:
    s_sub_u32 s2, s2, 320
    s_cmp_ge_u32 s2, 135
    s_cbranch_scc1 late_m1
    s_load_dwordx2 s[8:9], s[0:1], 80
    s_mov_b32 s10, 2211840
    s_mov_b32 s11, 0x00020000
    s_mov_b32 s12, 1280
    s_mov_b32 s13, 10
    s_mov_b32 s14, 429496730
    s_mov_b32 s15, 55296
    s_mov_b32 s16, 32505856
    s_mov_b32 s24, 1024
    s_mov_b32 s25, 512
    s_mov_b32 s26, 256
    s_mov_b32 s27, 128
    s_mov_b32 s28, 2048
    s_branch late_go
late_m1:
    s_sub_u32 s2, s2, 135
    s_branch g1_lend
late_go:
    s_lshl_b32 s2, s2, 2
    s_add_u32 s2, s2, s3
    s_mul_hi_u32 s17, s2, s14
    s_mul_i32 s18, s17, s13
    s_sub_u32 s18, s2, s18
    s_mul_i32 s19, s17, s12
    s_lshl_b32 s19, s19, 5
    s_lshl_b32 s20, s18, 7
    s_add_u32 s19, s19, s20
    s_lshl_b32 s20, s12, 3
    v_lshrrev_b32 v2, 3, v1
    v_and_b32 v3, 7, v1
    v_mul_lo_u32 v2, s12, v2
    v_lshl_add_u32 v2, v3, 4, v2
    s_waitcnt lgkmcnt(0)
    buffer_load_dwordx4 v[16:19], v2, s[8:11], s19 offen nt
    s_add_u32 s19, s19, s20
    buffer_load_dwordx4 v[20:23], v2, s[8:11], s19 offen nt
    s_add_u32 s19, s19, s20
    buffer_load_dwordx4 v[24:27], v2, s[8:11], s19 offen nt
    s_add_u32 s19, s19, s20
    buffer_load_dwordx4 v[28:31], v2, s[8:11], s19 offen nt
    s_add_u32 s19, s19, s20
    s_lshl_b32 s21, s3, 12
    v_lshlrev_b32 v5, 4, v1
    v_add_u32 v6, s21, v5
    v_and_b32 v7, 3, v1
    v_lshlrev_b32 v7, 3, v7
    v_add_u32 v7, s21, v7
    v_bfe_u32 v8, v1, 5, 1
    v_mul_lo_u32 v8, s24, v8
    v_add_u32 v7, v7, v8
    v_bfe_u32 v8, v1, 4, 1
    v_mul_lo_u32 v8, s25, v8
    v_add_u32 v7, v7, v8
    v_bfe_u32 v8, v1, 3, 1
    v_mul_lo_u32 v8, s26, v8
    v_add_u32 v7, v7, v8
    v_bfe_u32 v8, v1, 2, 1
    v_mul_lo_u32 v8, s27, v8
    v_add_u32 v7, v7, v8
    v_add_u32 v8, s28, v7
    s_lshl_b32 s18, s18, 2
    s_mul_i32 s18, s18, s15
    s_lshl_b32 s17, s17, 10
    s_add_u32 s18, s18, s17
    s_add_u32 s18, s18, s16
    s_waitcnt vmcnt(3)
    ds_write_b128 v6, v[16:19] offset:0
    s_waitcnt vmcnt(2)
    ds_write_b128 v6, v[20:23] offset:1024
    s_waitcnt vmcnt(1)
    ds_write_b128 v6, v[24:27] offset:2048
    s_waitcnt vmcnt(0)
    ds_write_b128 v6, v[28:31] offset:3072
    s_waitcnt lgkmcnt(0)
    ds_read_b64_tr_b16 v[32:33], v7 offset:0
    ds_read_b64_tr_b16 v[34:35], v8 offset:0
    ds_read_b64_tr_b16 v[36:37], v7 offset:32
    ds_read_b64_tr_b16 v[38:39], v8 offset:32
    ds_read_b64_tr_b16 v[40:41], v7 offset:64
    ds_read_b64_tr_b16 v[42:43], v8 offset:64
    ds_read_b64_tr_b16 v[44:45], v7 offset:96
    ds_read_b64_tr_b16 v[46:47], v8 offset:96
    s_waitcnt lgkmcnt(6)
    buffer_store_dwordx4 v[32:35], v5, s[4:7], s18 offen sc1
    s_add_u32 s18, s18, s15
    s_waitcnt lgkmcnt(4)
    buffer_store_dwordx4 v[36:39], v5, s[4:7], s18 offen sc1
    s_add_u32 s18, s18, s15
    s_waitcnt lgkmcnt(2)
    buffer_store_dwordx4 v[40:43], v5, s[4:7], s18 offen sc1
    s_add_u32 s18, s18, s15
    s_waitcnt lgkmcnt(0)
    buffer_store_dwordx4 v[44:47], v5, s[4:7], s18 offen sc1
    s_add_u32 s18, s18, s15
    s_add_u32 s34, s34, 128
    s_branch g1_late
g1_lend:
    v_lshlrev_b32 v1, 4, v1
    s_branch g1_end
g1_q:
    s_sub_u32 s13, s13, 128
    s_mul_i32 s12, s13, 43
    s_lshr_b32 s12, s12, 7
    s_mul_i32 s22, s12, 3
    s_sub_u32 s22, s13, s22
    s_mov_b32 s23, 3
    s_cmp_ge_u32 s12, 16
    s_cbranch_scc1 g1_f
    s_lshl_b32 s24, s12, 2
    s_add_u32 s24, s24, s3
    s_mul_i32 s20, s24, 81920
    s_add_u32 s21, s20, 40960
    s_lshl_b32 s24, s24, 12
    s_add_u32 s24, s24, 83886080
    s_mov_b32 s25, 262144
    buffer_load_dwordx4 v[192:195], v1, s[4:7], s20 offen offset:0
    buffer_load_dwordx4 v[196:199], v1, s[4:7], s20 offen offset:1024
    buffer_load_dwordx4 v[200:203], v1, s[4:7], s20 offen offset:2048
    buffer_load_dwordx4 v[204:207], v1, s[4:7], s20 offen offset:3072
    s_add_u32 s20, s20, 4096
    buffer_load_dwordx4 v[208:211], v1, s[4:7], s20 offen offset:0
    buffer_load_dwordx4 v[212:215], v1, s[4:7], s20 offen offset:1024
    buffer_load_dwordx4 v[216:219], v1, s[4:7], s20 offen offset:2048
    buffer_load_dwordx4 v[220:223], v1, s[4:7], s20 offen offset:3072
    s_add_u32 s20, s20, 4096
    buffer_load_dwordx4 v[224:227], v1, s[4:7], s20 offen offset:0
    buffer_load_dwordx4 v[228:231], v1, s[4:7], s20 offen offset:1024
    buffer_load_dwordx4 v[232:235], v1, s[4:7], s20 offen offset:2048
    buffer_load_dwordx4 v[236:239], v1, s[4:7], s20 offen offset:3072
    s_add_u32 s20, s20, 4096
    buffer_load_dwordx4 v[240:243], v1, s[4:7], s20 offen offset:0
    buffer_load_dwordx4 v[244:247], v1, s[4:7], s20 offen offset:1024
    buffer_load_dwordx4 v[248:251], v1, s[4:7], s20 offen offset:2048
    buffer_load_dwordx4 v[252:255], v1, s[4:7], s20 offen offset:3072
    s_add_u32 s20, s20, 4096
    buffer_load_dwordx4 a[0:3], v1, s[4:7], s20 offen offset:0
    buffer_load_dwordx4 a[4:7], v1, s[4:7], s20 offen offset:1024
    buffer_load_dwordx4 a[8:11], v1, s[4:7], s20 offen offset:2048
    buffer_load_dwordx4 a[12:15], v1, s[4:7], s20 offen offset:3072
    s_add_u32 s20, s20, 4096
    buffer_load_dwordx4 a[16:19], v1, s[4:7], s20 offen offset:0
    buffer_load_dwordx4 a[20:23], v1, s[4:7], s20 offen offset:1024
    buffer_load_dwordx4 a[24:27], v1, s[4:7], s20 offen offset:2048
    buffer_load_dwordx4 a[28:31], v1, s[4:7], s20 offen offset:3072
    s_add_u32 s20, s20, 4096
    buffer_load_dwordx4 a[32:35], v1, s[4:7], s20 offen offset:0
    buffer_load_dwordx4 a[36:39], v1, s[4:7], s20 offen offset:1024
    buffer_load_dwordx4 a[40:43], v1, s[4:7], s20 offen offset:2048
    buffer_load_dwordx4 a[44:47], v1, s[4:7], s20 offen offset:3072
    s_add_u32 s20, s20, 4096
    buffer_load_dwordx4 a[48:51], v1, s[4:7], s20 offen offset:0
    buffer_load_dwordx4 a[52:55], v1, s[4:7], s20 offen offset:1024
    buffer_load_dwordx4 a[56:59], v1, s[4:7], s20 offen offset:2048
    buffer_load_dwordx4 a[60:63], v1, s[4:7], s20 offen offset:3072
    s_add_u32 s20, s20, 4096
    buffer_load_dwordx4 a[64:67], v1, s[4:7], s20 offen offset:0
    buffer_load_dwordx4 a[68:71], v1, s[4:7], s20 offen offset:1024
    buffer_load_dwordx4 a[72:75], v1, s[4:7], s20 offen offset:2048
    buffer_load_dwordx4 a[76:79], v1, s[4:7], s20 offen offset:3072
    s_add_u32 s20, s20, 4096
    buffer_load_dwordx4 a[80:83], v1, s[4:7], s20 offen offset:0
    buffer_load_dwordx4 a[84:87], v1, s[4:7], s20 offen offset:1024
    buffer_load_dwordx4 a[88:91], v1, s[4:7], s20 offen offset:2048
    buffer_load_dwordx4 a[92:95], v1, s[4:7], s20 offen offset:3072
    s_add_u32 s20, s20, 4096
    buffer_load_dwordx4 a[96:99], v1, s[4:7], s21 offen offset:0
    buffer_load_dwordx4 a[100:103], v1, s[4:7], s21 offen offset:1024
    buffer_load_dwordx4 a[104:107], v1, s[4:7], s21 offen offset:2048
    buffer_load_dwordx4 a[108:111], v1, s[4:7], s21 offen offset:3072
    s_add_u32 s21, s21, 4096
    buffer_load_dwordx4 a[112:115], v1, s[4:7], s21 offen offset:0
    buffer_load_dwordx4 a[116:119], v1, s[4:7], s21 offen offset:1024
    buffer_load_dwordx4 a[120:123], v1, s[4:7], s21 offen offset:2048
    buffer_load_dwordx4 a[124:127], v1, s[4:7], s21 offen offset:3072
    s_add_u32 s21, s21, 4096
    buffer_load_dwordx4 a[128:131], v1, s[4:7], s21 offen offset:0
    buffer_load_dwordx4 a[132:135], v1, s[4:7], s21 offen offset:1024
    buffer_load_dwordx4 a[136:139], v1, s[4:7], s21 offen offset:2048
    buffer_load_dwordx4 a[140:143], v1, s[4:7], s21 offen offset:3072
    s_add_u32 s21, s21, 4096
    buffer_load_dwordx4 a[144:147], v1, s[4:7], s21 offen offset:0
    buffer_load_dwordx4 a[148:151], v1, s[4:7], s21 offen offset:1024
    buffer_load_dwordx4 a[152:155], v1, s[4:7], s21 offen offset:2048
    buffer_load_dwordx4 a[156:159], v1, s[4:7], s21 offen offset:3072
    s_add_u32 s21, s21, 4096
    buffer_load_dwordx4 a[160:163], v1, s[4:7], s21 offen offset:0
    buffer_load_dwordx4 a[164:167], v1, s[4:7], s21 offen offset:1024
    buffer_load_dwordx4 a[168:171], v1, s[4:7], s21 offen offset:2048
    buffer_load_dwordx4 a[172:175], v1, s[4:7], s21 offen offset:3072
    s_add_u32 s21, s21, 4096
    buffer_load_dwordx4 a[176:179], v1, s[4:7], s21 offen offset:0
    buffer_load_dwordx4 a[180:183], v1, s[4:7], s21 offen offset:1024
    buffer_load_dwordx4 a[184:187], v1, s[4:7], s21 offen offset:2048
    buffer_load_dwordx4 a[188:191], v1, s[4:7], s21 offen offset:3072
    s_add_u32 s21, s21, 4096
    buffer_load_dwordx4 a[192:195], v1, s[4:7], s21 offen offset:0
    buffer_load_dwordx4 a[196:199], v1, s[4:7], s21 offen offset:1024
    buffer_load_dwordx4 a[200:203], v1, s[4:7], s21 offen offset:2048
    buffer_load_dwordx4 a[204:207], v1, s[4:7], s21 offen offset:3072
    s_add_u32 s21, s21, 4096
    buffer_load_dwordx4 a[208:211], v1, s[4:7], s21 offen offset:0
    buffer_load_dwordx4 a[212:215], v1, s[4:7], s21 offen offset:1024
    buffer_load_dwordx4 a[216:219], v1, s[4:7], s21 offen offset:2048
    buffer_load_dwordx4 a[220:223], v1, s[4:7], s21 offen offset:3072
    s_add_u32 s21, s21, 4096
    buffer_load_dwordx4 a[224:227], v1, s[4:7], s21 offen offset:0
    buffer_load_dwordx4 a[228:231], v1, s[4:7], s21 offen offset:1024
    buffer_load_dwordx4 a[232:235], v1, s[4:7], s21 offen offset:2048
    buffer_load_dwordx4 a[236:239], v1, s[4:7], s21 offen offset:3072
    s_add_u32 s21, s21, 4096
    buffer_load_dwordx4 a[240:243], v1, s[4:7], s21 offen offset:0
    buffer_load_dwordx4 a[244:247], v1, s[4:7], s21 offen offset:1024
    buffer_load_dwordx4 a[248:251], v1, s[4:7], s21 offen offset:2048
    buffer_load_dwordx4 a[252:255], v1, s[4:7], s21 offen offset:3072
    s_add_u32 s21, s21, 4096
    s_mov_b32 s26, 0
    s_mul_i32 s27, s22, 40960
    s_mul_i32 s28, s3, 10240
    s_add_u32 s27, s27, s28
    s_add_u32 s27, s27, 35651584
    s_add_u32 s28, s28, s26
    s_mov_b32 m0, s28
    s_add_u32 s28, s28, 4096
    buffer_load_dwordx4 v1, s[4:7], s27 offen offset:0 lds
    buffer_load_dwordx4 v1, s[4:7], s27 offen offset:1024 lds
    buffer_load_dwordx4 v1, s[4:7], s27 offen offset:2048 lds
    buffer_load_dwordx4 v1, s[4:7], s27 offen offset:3072 lds
    s_add_u32 s27, s27, 4096
    s_mov_b32 m0, s28
    s_add_u32 s28, s28, 4096
    buffer_load_dwordx4 v1, s[4:7], s27 offen offset:0 lds
    buffer_load_dwordx4 v1, s[4:7], s27 offen offset:1024 lds
    buffer_load_dwordx4 v1, s[4:7], s27 offen offset:2048 lds
    buffer_load_dwordx4 v1, s[4:7], s27 offen offset:3072 lds
    s_add_u32 s27, s27, 4096
    s_mov_b32 m0, s28
    s_add_u32 s28, s28, 4096
    buffer_load_dwordx4 v1, s[4:7], s27 offen offset:0 lds
    buffer_load_dwordx4 v1, s[4:7], s27 offen offset:1024 lds
    s_waitcnt vmcnt(0)
g1q_loop:
    s_waitcnt vmcnt(4)
    s_barrier
    v_add_u32 v2, s26, v1
    s_xor_b32 s26, s26, 40960
    s_add_u32 s29, s22, s23
    s_cmp_ge_u32 s29, 64
    s_cbranch_scc1 g1q_nodma
    s_mul_i32 s27, s29, 40960
    s_mul_i32 s28, s3, 10240
    s_add_u32 s27, s27, s28
    s_add_u32 s27, s27, 35651584
    s_add_u32 s28, s28, s26
    s_mov_b32 m0, s28
    s_add_u32 s28, s28, 4096
    buffer_load_dwordx4 v1, s[4:7], s27 offen offset:0 lds
    buffer_load_dwordx4 v1, s[4:7], s27 offen offset:1024 lds
    buffer_load_dwordx4 v1, s[4:7], s27 offen offset:2048 lds
    buffer_load_dwordx4 v1, s[4:7], s27 offen offset:3072 lds
    s_add_u32 s27, s27, 4096
    s_mov_b32 m0, s28
    s_add_u32 s28, s28, 4096
    buffer_load_dwordx4 v1, s[4:7], s27 offen offset:0 lds
    buffer_load_dwordx4 v1, s[4:7], s27 offen offset:1024 lds
    buffer_load_dwordx4 v1, s[4:7], s27 offen offset:2048 lds
    buffer_load_dwordx4 v1, s[4:7], s27 offen offset:3072 lds
    s_add_u32 s27, s27, 4096
    s_mov_b32 m0, s28
    s_add_u32 s28, s28, 4096
    buffer_load_dwordx4 v1, s[4:7], s27 offen offset:0 lds
    buffer_load_dwordx4 v1, s[4:7], s27 offen offset:1024 lds
g1q_nodma:
    ds_read_b128 v[48:51], v2 offset:0
    ds_read_b128 v[52:55], v2 offset:20480
    ds_read_b128 v[56:59], v2 offset:1024
    ds_read_b128 v[60:63], v2 offset:21504
    s_waitcnt lgkmcnt(2)
    v_mfma_f32_16x16x32_bf16 v[16:19], v[192:195], v[48:51], 0
    v_mfma_f32_16x16x32_bf16 v[20:23], v[192:195], v[52:55], 0
    v_mfma_f32_16x16x32_bf16 v[24:27], a[16:19], v[48:51], 0
    v_mfma_f32_16x16x32_bf16 v[28:31], a[16:19], v[52:55], 0
    v_mfma_f32_16x16x32_bf16 v[32:35], a[96:99], v[48:51], 0
    v_mfma_f32_16x16x32_bf16 v[36:39], a[96:99], v[52:55], 0
    v_mfma_f32_16x16x32_bf16 v[40:43], a[176:179], v[48:51], 0
    v_mfma_f32_16x16x32_bf16 v[44:47], a[176:179], v[52:55], 0
    ds_read_b128 v[48:51], v2 offset:2048
    ds_read_b128 v[52:55], v2 offset:22528
    s_waitcnt lgkmcnt(2)
    v_mfma_f32_16x16x32_bf16 v[16:19], v[196:199], v[56:59], v[16:19]
    v_mfma_f32_16x16x32_bf16 v[20:23], v[196:199], v[60:63], v[20:23]
    v_mfma_f32_16x16x32_bf16 v[24:27], a[20:23], v[56:59], v[24:27]
    v_mfma_f32_16x16x32_bf16 v[28:31], a[20:23], v[60:63], v[28:31]
    v_mfma_f32_16x16x32_bf16 v[32:35], a[100:103], v[56:59], v[32:35]
    v_mfma_f32_16x16x32_bf16 v[36:39], a[100:103], v[60:63], v[36:39]
    v_mfma_f32_16x16x32_bf16 v[40:43], a[180:183], v[56:59], v[40:43]
    v_mfma_f32_16x16x32_bf16 v[44:47], a[180:183], v[60:63], v[44:47]
    ds_read_b128 v[56:59], v2 offset:3072
    ds_read_b128 v[60:63], v2 offset:23552
    s_waitcnt lgkmcnt(2)
    v_mfma_f32_16x16x32_bf16 v[16:19], v[200:203], v[48:51], v[16:19]
    v_mfma_f32_16x16x32_bf16 v[20:23], v[200:203], v[52:55], v[20:23]
    v_mfma_f32_16x16x32_bf16 v[24:27], a[24:27], v[48:51], v[24:27]
    v_mfma_f32_16x16x32_bf16 v[28:31], a[24:27], v[52:55], v[28:31]
    v_mfma_f32_16x16x32_bf16 v[32:35], a[104:107], v[48:51], v[32:35]
    v_mfma_f32_16x16x32_bf16 v[36:39], a[104:107], v[52:55], v[36:39]
    v_mfma_f32_16x16x32_bf16 v[40:43], a[184:187], v[48:51], v[40:43]
    v_mfma_f32_16x16x32_bf16 v[44:47], a[184:187], v[52:55], v[44:47]
    ds_read_b128 v[48:51], v2 offset:4096
    ds_read_b128 v[52:55], v2 offset:24576
    s_waitcnt lgkmcnt(2)
    v_mfma_f32_16x16x32_bf16 v[16:19], v[204:207], v[56:59], v[16:19]
    v_mfma_f32_16x16x32_bf16 v[20:23], v[204:207], v[60:63], v[20:23]
    v_mfma_f32_16x16x32_bf16 v[24:27], a[28:31], v[56:59], v[24:27]
    v_mfma_f32_16x16x32_bf16 v[28:31], a[28:31], v[60:63], v[28:31]
    v_mfma_f32_16x16x32_bf16 v[32:35], a[108:111], v[56:59], v[32:35]
    v_mfma_f32_16x16x32_bf16 v[36:39], a[108:111], v[60:63], v[36:39]
    v_mfma_f32_16x16x32_bf16 v[40:43], a[188:191], v[56:59], v[40:43]
    v_mfma_f32_16x16x32_bf16 v[44:47], a[188:191], v[60:63], v[44:47]
    ds_read_b128 v[56:59], v2 offset:5120
    ds_read_b128 v[60:63], v2 offset:25600
    s_waitcnt lgkmcnt(2)
    v_mfma_f32_16x16x32_bf16 v[16:19], v[208:211], v[48:51], v[16:19]
    v_mfma_f32_16x16x32_bf16 v[20:23], v[208:211], v[52:55], v[20:23]
    v_mfma_f32_16x16x32_bf16 v[24:27], a[32:35], v[48:51], v[24:27]
    v_mfma_f32_16x16x32_bf16 v[28:31], a[32:35], v[52:55], v[28:31]
    v_mfma_f32_16x16x32_bf16 v[32:35], a[112:115], v[48:51], v[32:35]
    v_mfma_f32_16x16x32_bf16 v[36:39], a[112:115], v[52:55], v[36:39]
    v_mfma_f32_16x16x32_bf16 v[40:43], a[192:195], v[48:51], v[40:43]
    v_mfma_f32_16x16x32_bf16 v[44:47], a[192:195], v[52:55], v[44:47]
    ds_read_b128 v[48:51], v2 offset:6144
    ds_read_b128 v[52:55], v2 offset:26624
    s_waitcnt lgkmcnt(2)
    v_mfma_f32_16x16x32_bf16 v[16:19], v[212:215], v[56:59], v[16:19]
    v_mfma_f32_16x16x32_bf16 v[20:23], v[212:215], v[60:63], v[20:23]
    v_mfma_f32_16x16x32_bf16 v[24:27], a[36:39], v[56:59], v[24:27]
    v_mfma_f32_16x16x32_bf16 v[28:31], a[36:39], v[60:63], v[28:31]
    v_mfma_f32_16x16x32_bf16 v[32:35], a[116:119], v[56:59], v[32:35]
    v_mfma_f32_16x16x32_bf16 v[36:39], a[116:119], v[60:63], v[36:39]
    v_mfma_f32_16x16x32_bf16 v[40:43], a[196:199], v[56:59], v[40:43]
    v_mfma_f32_16x16x32_bf16 v[44:47], a[196:199], v[60:63], v[44:47]
    ds_read_b128 v[56:59], v2 offset:7168
    ds_read_b128 v[60:63], v2 offset:27648
    s_waitcnt lgkmcnt(2)
    v_mfma_f32_16x16x32_bf16 v[16:19], v[216:219], v[48:51], v[16:19]
    v_mfma_f32_16x16x32_bf16 v[20:23], v[216:219], v[52:55], v[20:23]
    v_mfma_f32_16x16x32_bf16 v[24:27], a[40:43], v[48:51], v[24:27]
    v_mfma_f32_16x16x32_bf16 v[28:31], a[40:43], v[52:55], v[28:31]
    v_mfma_f32_16x16x32_bf16 v[32:35], a[120:123], v[48:51], v[32:35]
    v_mfma_f32_16x16x32_bf16 v[36:39], a[120:123], v[52:55], v[36:39]
    v_mfma_f32_16x16x32_bf16 v[40:43], a[200:203], v[48:51], v[40:43]
    v_mfma_f32_16x16x32_bf16 v[44:47], a[200:203], v[52:55], v[44:47]
    ds_read_b128 v[48:51], v2 offset:8192
    ds_read_b128 v[52:55], v2 offset:28672
    s_waitcnt lgkmcnt(2)
    v_mfma_f32_16x16x32_bf16 v[16:19], v[220:223], v[56:59], v[16:19]
    v_mfma_f32_16x16x32_bf16 v[20:23], v[220:223], v[60:63], v[20:23]
    v_mfma_f32_16x16x32_bf16 v[24:27], a[44:47], v[56:59], v[24:27]
    v_mfma_f32_16x16x32_bf16 v[28:31], a[44:47], v[60:63], v[28:31]
    v_mfma_f32_16x16x32_bf16 v[32:35], a[124:127], v[56:59], v[32:35]
    v_mfma_f32_16x16x32_bf16 v[36:39], a[124:127], v[60:63], v[36:39]
    v_mfma_f32_16x16x32_bf16 v[40:43], a[204:207], v[56:59], v[40:43]
    v_mfma_f32_16x16x32_bf16 v[44:47], a[204:207], v[60:63], v[44:47]
    ds_read_b128 v[56:59], v2 offset:9216
    ds_read_b128 v[60:63], v2 offset:29696
    s_waitcnt lgkmcnt(2)
    v_mfma_f32_16x16x32_bf16 v[16:19], v[224:227], v[48:51], v[16:19]
    v_mfma_f32_16x16x32_bf16 v[20:23], v[224:227], v[52:55], v[20:23]
    v_mfma_f32_16x16x32_bf16 v[24:27], a[48:51], v[48:51], v[24:27]
    v_mfma_f32_16x16x32_bf16 v[28:31], a[48:51], v[52:55], v[28:31]
    v_mfma_f32_16x16x32_bf16 v[32:35], a[128:131], v[48:51], v[32:35]
    v_mfma_f32_16x16x32_bf16 v[36:39], a[128:131], v[52:55], v[36:39]
    v_mfma_f32_16x16x32_bf16 v[40:43], a[208:211], v[48:51], v[40:43]
    v_mfma_f32_16x16x32_bf16 v[44:47], a[208:211], v[52:55], v[44:47]
    ds_read_b128 v[48:51], v2 offset:10240
    ds_read_b128 v[52:55], v2 offset:30720
    s_waitcnt lgkmcnt(2)
    v_mfma_f32_16x16x32_bf16 v[16:19], v[228:231], v[56:59], v[16:19]
    v_mfma_f32_16x16x32_bf16 v[20:23], v[228:231], v[60:63], v[20:23]
    v_mfma_f32_16x16x32_bf16 v[24:27], a[52:55], v[56:59], v[24:27]
    v_mfma_f32_16x16x32_bf16 v[28:31], a[52:55], v[60:63], v[28:31]
    v_mfma_f32_16x16x32_bf16 v[32:35], a[132:135], v[56:59], v[32:35]
    v_mfma_f32_16x16x32_bf16 v[36:39], a[132:135], v[60:63], v[36:39]
    v_mfma_f32_16x16x32_bf16 v[40:43], a[212:215], v[56:59], v[40:43]
    v_mfma_f32_16x16x32_bf16 v[44:47], a[212:215], v[60:63], v[44:47]
    ds_read_b128 v[56:59], v2 offset:11264
    ds_read_b128 v[60:63], v2 offset:31744
    s_waitcnt lgkmcnt(2)
    v_mfma_f32_16x16x32_bf16 v[16:19], v[232:235], v[48:51], v[16:19]
    v_mfma_f32_16x16x32_bf16 v[20:23], v[232:235], v[52:55], v[20:23]
    v_mfma_f32_16x16x32_bf16 v[24:27], a[56:59], v[48:51], v[24:27]
    v_mfma_f32_16x16x32_bf16 v[28:31], a[56:59], v[52:55], v[28:31]
    v_mfma_f32_16x16x32_bf16 v[32:35], a[136:139], v[48:51], v[32:35]
    v_mfma_f32_16x16x32_bf16 v[36:39], a[136:139], v[52:55], v[36:39]
    v_mfma_f32_16x16x32_bf16 v[40:43], a[216:219], v[48:51], v[40:43]
    v_mfma_f32_16x16x32_bf16 v[44:47], a[216:219], v[52:55], v[44:47]
    ds_read_b128 v[48:51], v2 offset:12288
    ds_read_b128 v[52:55], v2 offset:32768
    s_waitcnt lgkmcnt(2)
    v_mfma_f32_16x16x32_bf16 v[16:19], v[236:239], v[56:59], v[16:19]
    v_mfma_f32_16x16x32_bf16 v[20:23], v[236:239], v[60:63], v[20:23]
    v_mfma_f32_16x16x32_bf16 v[24:27], a[60:63], v[56:59], v[24:27]
    v_mfma_f32_16x16x32_bf16 v[28:31], a[60:63], v[60:63], v[28:31]
    v_mfma_f32_16x16x32_bf16 v[32:35], a[140:143], v[56:59], v[32:35]
    v_mfma_f32_16x16x32_bf16 v[36:39], a[140:143], v[60:63], v[36:39]
    v_mfma_f32_16x16x32_bf16 v[40:43], a[220:223], v[56:59], v[40:43]
    v_mfma_f32_16x16x32_bf16 v[44:47], a[220:223], v[60:63], v[44:47]
    ds_read_b128 v[56:59], v2 offset:13312
    ds_read_b128 v[60:63], v2 offset:33792
    s_waitcnt lgkmcnt(2)
    v_mfma_f32_16x16x32_bf16 v[16:19], v[240:243], v[48:51], v[16:19]
    v_mfma_f32_16x16x32_bf16 v[20:23], v[240:243], v[52:55], v[20:23]
    v_mfma_f32_16x16x32_bf16 v[24:27], a[64:67], v[48:51], v[24:27]
    v_mfma_f32_16x16x32_bf16 v[28:31], a[64:67], v[52:55], v[28:31]
    v_mfma_f32_16x16x32_bf16 v[32:35], a[144:147], v[48:51], v[32:35]
    v_mfma_f32_16x16x32_bf16 v[36:39], a[144:147], v[52:55], v[36:39]
    v_mfma_f32_16x16x32_bf16 v[40:43], a[224:227], v[48:51], v[40:43]
    v_mfma_f32_16x16x32_bf16 v[44:47], a[224:227], v[52:55], v[44:47]
    ds_read_b128 v[48:51], v2 offset:14336
    ds_read_b128 v[52:55], v2 offset:34816
    s_waitcnt lgkmcnt(2)
    v_mfma_f32_16x16x32_bf16 v[16:19], v[244:247], v[56:59], v[16:19]
    v_mfma_f32_16x16x32_bf16 v[20:23], v[244:247], v[60:63], v[20:23]
    v_mfma_f32_16x16x32_bf16 v[24:27], a[68:71], v[56:59], v[24:27]
    v_mfma_f32_16x16x32_bf16 v[28:31], a[68:71], v[60:63], v[28:31]
    v_mfma_f32_16x16x32_bf16 v[32:35], a[148:151], v[56:59], v[32:35]
    v_mfma_f32_16x16x32_bf16 v[36:39], a[148:151], v[60:63], v[36:39]
    v_mfma_f32_16x16x32_bf16 v[40:43], a[228:231], v[56:59], v[40:43]
    v_mfma_f32_16x16x32_bf16 v[44:47], a[228:231], v[60:63], v[44:47]
    ds_read_b128 v[56:59], v2 offset:15360
    ds_read_b128 v[60:63], v2 offset:35840
    s_waitcnt lgkmcnt(2)
    v_mfma_f32_16x16x32_bf16 v[16:19], v[248:251], v[48:51], v[16:19]
    v_mfma_f32_16x16x32_bf16 v[20:23], v[248:251], v[52:55], v[20:23]
    v_mfma_f32_16x16x32_bf16 v[24:27], a[72:75], v[48:51], v[24:27]
    v_mfma_f32_16x16x32_bf16 v[28:31], a[72:75], v[52:55], v[28:31]
    v_mfma_f32_16x16x32_bf16 v[32:35], a[152:155], v[48:51], v[32:35]
    v_mfma_f32_16x16x32_bf16 v[36:39], a[152:155], v[52:55], v[36:39]
    v_mfma_f32_16x16x32_bf16 v[40:43], a[232:235], v[48:51], v[40:43]
    v_mfma_f32_16x16x32_bf16 v[44:47], a[232:235], v[52:55], v[44:47]
    ds_read_b128 v[48:51], v2 offset:16384
    ds_read_b128 v[52:55], v2 offset:36864
    s_waitcnt lgkmcnt(2)
    v_mfma_f32_16x16x32_bf16 v[16:19], v[252:255], v[56:59], v[16:19]
    v_mfma_f32_16x16x32_bf16 v[20:23], v[252:255], v[60:63], v[20:23]
    v_mfma_f32_16x16x32_bf16 v[24:27], a[76:79], v[56:59], v[24:27]
    v_mfma_f32_16x16x32_bf16 v[28:31], a[76:79], v[60:63], v[28:31]
    v_mfma_f32_16x16x32_bf16 v[32:35], a[156:159], v[56:59], v[32:35]
    v_mfma_f32_16x16x32_bf16 v[36:39], a[156:159], v[60:63], v[36:39]
    v_mfma_f32_16x16x32_bf16 v[40:43], a[236:239], v[56:59], v[40:43]
    v_mfma_f32_16x16x32_bf16 v[44:47], a[236:239], v[60:63], v[44:47]
    ds_read_b128 v[56:59], v2 offset:17408
    ds_read_b128 v[60:63], v2 offset:37888
    s_waitcnt lgkmcnt(2)
    v_mfma_f32_16x16x32_bf16 v[16:19], a[0:3], v[48:51], v[16:19]
    v_mfma_f32_16x16x32_bf16 v[20:23], a[0:3], v[52:55], v[20:23]
    v_mfma_f32_16x16x32_bf16 v[24:27], a[80:83], v[48:51], v[24:27]
    v_mfma_f32_16x16x32_bf16 v[28:31], a[80:83], v[52:55], v[28:31]
    v_mfma_f32_16x16x32_bf16 v[32:35], a[160:163], v[48:51], v[32:35]
    v_mfma_f32_16x16x32_bf16 v[36:39], a[160:163], v[52:55], v[36:39]
    v_mfma_f32_16x16x32_bf16 v[40:43], a[240:243], v[48:51], v[40:43]
    v_mfma_f32_16x16x32_bf16 v[44:47], a[240:243], v[52:55], v[44:47]
    ds_read_b128 v[48:51], v2 offset:18432
    ds_read_b128 v[52:55], v2 offset:38912
    s_waitcnt lgkmcnt(2)
    v_mfma_f32_16x16x32_bf16 v[16:19], a[4:7], v[56:59], v[16:19]
    v_mfma_f32_16x16x32_bf16 v[20:23], a[4:7], v[60:63], v[20:23]
    v_mfma_f32_16x16x32_bf16 v[24:27], a[84:87], v[56:59], v[24:27]
    v_mfma_f32_16x16x32_bf16 v[28:31], a[84:87], v[60:63], v[28:31]
    v_mfma_f32_16x16x32_bf16 v[32:35], a[164:167], v[56:59], v[32:35]
    v_mfma_f32_16x16x32_bf16 v[36:39], a[164:167], v[60:63], v[36:39]
    v_mfma_f32_16x16x32_bf16 v[40:43], a[244:247], v[56:59], v[40:43]
    v_mfma_f32_16x16x32_bf16 v[44:47], a[244:247], v[60:63], v[44:47]
    ds_read_b128 v[56:59], v2 offset:19456
    ds_read_b128 v[60:63], v2 offset:39936
    s_waitcnt lgkmcnt(2)
    v_mfma_f32_16x16x32_bf16 v[16:19], a[8:11], v[48:51], v[16:19]
    v_mfma_f32_16x16x32_bf16 v[20:23], a[8:11], v[52:55], v[20:23]
    v_mfma_f32_16x16x32_bf16 v[24:27], a[88:91], v[48:51], v[24:27]
    v_mfma_f32_16x16x32_bf16 v[28:31], a[88:91], v[52:55], v[28:31]
    v_mfma_f32_16x16x32_bf16 v[32:35], a[168:171], v[48:51], v[32:35]
    v_mfma_f32_16x16x32_bf16 v[36:39], a[168:171], v[52:55], v[36:39]
    v_mfma_f32_16x16x32_bf16 v[40:43], a[248:251], v[48:51], v[40:43]
    v_mfma_f32_16x16x32_bf16 v[44:47], a[248:251], v[52:55], v[44:47]
    s_waitcnt lgkmcnt(0)
    v_mfma_f32_16x16x32_bf16 v[16:19], a[12:15], v[56:59], v[16:19]
    v_mfma_f32_16x16x32_bf16 v[20:23], a[12:15], v[60:63], v[20:23]
    v_mfma_f32_16x16x32_bf16 v[24:27], a[92:95], v[56:59], v[24:27]
    v_mfma_f32_16x16x32_bf16 v[28:31], a[92:95], v[60:63], v[28:31]
    v_mfma_f32_16x16x32_bf16 v[32:35], a[172:175], v[56:59], v[32:35]
    v_mfma_f32_16x16x32_bf16 v[36:39], a[172:175], v[60:63], v[36:39]
    v_mfma_f32_16x16x32_bf16 v[40:43], a[252:255], v[56:59], v[40:43]
    v_mfma_f32_16x16x32_bf16 v[44:47], a[252:255], v[60:63], v[44:47]
    s_mul_i32 s27, s22, s25
    s_add_u32 s27, s27, s24
    s_nop 6
    v_cvt_pk_bf16_f32 v64, v16, v17
    v_cvt_pk_bf16_f32 v65, v18, v19
    v_cvt_pk_bf16_f32 v66, v24, v25
    v_cvt_pk_bf16_f32 v67, v26, v27
    buffer_store_dwordx4 v[64:67], v1, s[4:7], s27 offen offset:0 sc1 nt
    v_cvt_pk_bf16_f32 v68, v20, v21
    v_cvt_pk_bf16_f32 v69, v22, v23
    v_cvt_pk_bf16_f32 v70, v28, v29
    v_cvt_pk_bf16_f32 v71, v30, v31
    buffer_store_dwordx4 v[68:71], v1, s[4:7], s27 offen offset:1024 sc1 nt
    v_cvt_pk_bf16_f32 v72, v32, v33
    v_cvt_pk_bf16_f32 v73, v34, v35
    v_cvt_pk_bf16_f32 v74, v40, v41
    v_cvt_pk_bf16_f32 v75, v42, v43
    buffer_store_dwordx4 v[72:75], v1, s[4:7], s27 offen offset:2048 sc1 nt
    v_cvt_pk_bf16_f32 v76, v36, v37
    v_cvt_pk_bf16_f32 v77, v38, v39
    v_cvt_pk_bf16_f32 v78, v44, v45
    v_cvt_pk_bf16_f32 v79, v46, v47
    buffer_store_dwordx4 v[76:79], v1, s[4:7], s27 offen offset:3072 sc1 nt
    s_mov_b32 s22, s29
    s_cmp_lt_u32 s22, 64
    s_cbranch_scc1 g1q_loop
    s_branch g1_end
g1_f:
    s_sub_u32 s34, s13, 48
    s_sub_u32 s35, s12, 16
    s_mov_b32 s36, s22
    v_lshrrev_b32 v1, 4, v1
g1_gu:
    s_mov_b32 s2, s34
    s_cmp_ge_u32 s2, 135
    s_cbranch_scc1 gu_m0
    s_load_dwordx2 s[8:9], s[0:1], 64
    s_mov_b32 s10, 2211840
    s_mov_b32 s11, 0x00020000
    s_mov_b32 s12, 3456
    s_mov_b32 s13, 27
    s_mov_b32 s14, 159072863
    s_mov_b32 s15, 20480
    s_mov_b32 s16, 15728640
    s_mov_b32 s24, 2048
    s_mov_b32 s25, 512
    s_mov_b32 s26, 1024
    s_mov_b32 s27, 128
    s_mov_b32 s28, 256
    s_branch gu_go
gu_m0:
    s_sub_u32 s2, s2, 135
    s_cmp_ge_u32 s2, 135
    s_cbranch_scc1 gu_m1
    s_load_dwordx2 s[8:9], s[0:1], 72
    s_mov_b32 s10, 2211840
    s_mov_b32 s11, 0x00020000
    s_mov_b32 s12, 3456
    s_mov_b32 s13, 27
    s_mov_b32 s14, 159072863
    s_mov_b32 s15, 20480
    s_mov_b32 s16, 18874368
    s_mov_b32 s24, 2048
    s_mov_b32 s25, 512
    s_mov_b32 s26, 1024
    s_mov_b32 s27, 128
    s_mov_b32 s28, 256
    s_branch gu_go
gu_m1:
    s_sub_u32 s2, s2, 135
    s_branch g1_guend
gu_go:
    s_lshl_b32 s2, s2, 2
    s_add_u32 s2, s2, s3
    s_mul_hi_u32 s17, s2, s14
    s_mul_i32 s18, s17, s13
    s_sub_u32 s18, s2, s18
    s_mul_i32 s19, s17, s12
    s_lshl_b32 s19, s19, 5
    s_lshl_b32 s20, s18, 7
    s_add_u32 s19, s19, s20
    s_lshl_b32 s20, s12, 3
    v_lshrrev_b32 v2, 3, v1
    v_and_b32 v3, 7, v1
    v_mul_lo_u32 v2, s12, v2
    v_lshl_add_u32 v2, v3, 4, v2
    s_waitcnt lgkmcnt(0)
    buffer_load_dwordx4 v[16:19], v2, s[8:11], s19 offen nt
    s_add_u32 s19, s19, s20
    buffer_load_dwordx4 v[20:23], v2, s[8:11], s19 offen nt
    s_add_u32 s19, s19, s20
    buffer_load_dwordx4 v[24:27], v2, s[8:11], s19 offen nt
    s_add_u32 s19, s19, s20
    buffer_load_dwordx4 v[28:31], v2, s[8:11], s19 offen nt
    s_add_u32 s19, s19, s20
    s_lshl_b32 s21, s3, 12
    v_lshlrev_b32 v5, 4, v1
    v_add_u32 v6, s21, v5
    v_and_b32 v7, 3, v1
    v_lshlrev_b32 v7, 3, v7
    v_add_u32 v7, s21, v7
    v_bfe_u32 v8, v1, 5, 1
    v_mul_lo_u32 v8, s24, v8
    v_add_u32 v7, v7, v8
    v_bfe_u32 v8, v1, 4, 1
    v_mul_lo_u32 v8, s25, v8
    v_add_u32 v7, v7, v8
    v_bfe_u32 v8, v1, 3, 1
    v_mul_lo_u32 v8, s26, v8
    v_add_u32 v7, v7, v8
    v_bfe_u32 v8, v1, 2, 1
    v_mul_lo_u32 v8, s27, v8
    v_add_u32 v7, v7, v8
    v_add_u32 v8, s28, v7
    s_lshl_b32 s18, s18, 2
    s_mul_i32 s18, s18, s15
    s_lshl_b32 s17, s17, 10
    s_add_u32 s18, s18, s17
    s_add_u32 s18, s18, s16
    s_waitcnt vmcnt(3)
    ds_write_b128 v6, v[16:19] offset:0
    s_waitcnt vmcnt(2)
    ds_write_b128 v6, v[20:23] offset:1024
    s_waitcnt vmcnt(1)
    ds_write_b128 v6, v[24:27] offset:2048
    s_waitcnt vmcnt(0)
    ds_write_b128 v6, v[28:31] offset:3072
    s_waitcnt lgkmcnt(0)
    ds_read_b64_tr_b16 v[32:33], v7 offset:0
    ds_read_b64_tr_b16 v[34:35], v8 offset:0
    ds_read_b64_tr_b16 v[36:37], v7 offset:32
    ds_read_b64_tr_b16 v[38:39], v8 offset:32
    ds_read_b64_tr_b16 v[40:41], v7 offset:64
    ds_read_b64_tr_b16 v[42:43], v8 offset:64
    ds_read_b64_tr_b16 v[44:45], v7 offset:96
    ds_read_b64_tr_b16 v[46:47], v8 offset:96
    s_waitcnt lgkmcnt(6)
    buffer_store_dwordx4 v[32:35], v5, s[4:7], s18 offen sc1
    s_add_u32 s18, s18, s15
    s_waitcnt lgkmcnt(4)
    buffer_store_dwordx4 v[36:39], v5, s[4:7], s18 offen sc1
    s_add_u32 s18, s18, s15
    s_waitcnt lgkmcnt(2)
    buffer_store_dwordx4 v[40:43], v5, s[4:7], s18 offen sc1
    s_add_u32 s18, s18, s15
    s_waitcnt lgkmcnt(0)
    buffer_store_dwordx4 v[44:47], v5, s[4:7], s18 offen sc1
    s_add_u32 s18, s18, s15
    s_add_u32 s34, s34, 48
    s_branch g1_gu
g1_guend:
    v_lshlrev_b32 v1, 4, v1
    s_mov_b32 s12, 47136896
    s_waitcnt vmcnt(0)
    s_mov_b64 exec, 1
    v_mov_b32 v5, 1
    buffer_atomic_add v5, off, s[4:7], s12 sc1
    s_mov_b64 exec, -1
    s_cmp_lg_u32 s3, 0
    s_cbranch_scc1 g1_guw_b
g1_guw:
    s_sub_u32 s50, s50, 1
    s_cbranch_scc1 w_end
    buffer_load_dword v5, off, s[4:7], s12 sc1
    s_waitcnt vmcnt(0)
    v_cmp_ne_u32 vcc, 191, v5
    s_cbranch_vccnz g1_guw
g1_guw_b:
    s_barrier
    s_mov_b32 s12, s35
    s_mov_b32 s22, s36
    s_mov_b32 s23, 3
    s_cmp_ge_u32 s12, 14
    s_cbranch_scc1 w_ph2
    s_lshl_b32 s24, s12, 2
    s_add_u32 s24, s24, s3
    s_min_u32 s24, s24, 53
    s_mul_i32 s20, s24, 40960
    s_add_u32 s21, s20, 18874368
    s_add_u32 s20, s20, 15728640
    s_lshl_b32 s24, s24, 10
    s_add_u32 s24, s24, 38797312
    s_mov_b32 s25, 110592
    buffer_load_dwordx4 v[192:195], v1, s[4:7], s20 offen offset:0
    buffer_load_dwordx4 v[196:199], v1, s[4:7], s20 offen offset:1024
    buffer_load_dwordx4 v[200:203], v1, s[4:7], s20 offen offset:2048
    buffer_load_dwordx4 v[204:207], v1, s[4:7], s20 offen offset:3072
    s_add_u32 s20, s20, 4096
    buffer_load_dwordx4 v[208:211], v1, s[4:7], s20 offen offset:0
    buffer_load_dwordx4 v[212:215], v1, s[4:7], s20 offen offset:1024
    buffer_load_dwordx4 v[216:219], v1, s[4:7], s20 offen offset:2048
    buffer_load_dwordx4 v[220:223], v1, s[4:7], s20 offen offset:3072
    s_add_u32 s20, s20, 4096
    buffer_load_dwordx4 v[224:227], v1, s[4:7], s20 offen offset:0
    buffer_load_dwordx4 v[228:231], v1, s[4:7], s20 offen offset:1024
    buffer_load_dwordx4 v[232:235], v1, s[4:7], s20 offen offset:2048
    buffer_load_dwordx4 v[236:239], v1, s[4:7], s20 offen offset:3072
    s_add_u32 s20, s20, 4096
    buffer_load_dwordx4 v[240:243], v1, s[4:7], s20 offen offset:0
    buffer_load_dwordx4 v[244:247], v1, s[4:7], s20 offen offset:1024
    buffer_load_dwordx4 v[248:251], v1, s[4:7], s20 offen offset:2048
    buffer_load_dwordx4 v[252:255], v1, s[4:7], s20 offen offset:3072
    s_add_u32 s20, s20, 4096
    buffer_load_dwordx4 a[0:3], v1, s[4:7], s20 offen offset:0
    buffer_load_dwordx4 a[4:7], v1, s[4:7], s20 offen offset:1024
    buffer_load_dwordx4 a[8:11], v1, s[4:7], s20 offen offset:2048
    buffer_load_dwordx4 a[12:15], v1, s[4:7], s20 offen offset:3072
    s_add_u32 s20, s20, 4096
    buffer_load_dwordx4 a[16:19], v1, s[4:7], s20 offen offset:0
    buffer_load_dwordx4 a[20:23], v1, s[4:7], s20 offen offset:1024
    buffer_load_dwordx4 a[24:27], v1, s[4:7], s20 offen offset:2048
    buffer_load_dwordx4 a[28:31], v1, s[4:7], s20 offen offset:3072
    s_add_u32 s20, s20, 4096
    buffer_load_dwordx4 a[32:35], v1, s[4:7], s20 offen offset:0
    buffer_load_dwordx4 a[36:39], v1, s[4:7], s20 offen offset:1024
    buffer_load_dwordx4 a[40:43], v1, s[4:7], s20 offen offset:2048
    buffer_load_dwordx4 a[44:47], v1, s[4:7], s20 offen offset:3072
    s_add_u32 s20, s20, 4096
    buffer_load_dwordx4 a[48:51], v1, s[4:7], s20 offen offset:0
    buffer_load_dwordx4 a[52:55], v1, s[4:7], s20 offen offset:1024
    buffer_load_dwordx4 a[56:59], v1, s[4:7], s20 offen offset:2048
    buffer_load_dwordx4 a[60:63], v1, s[4:7], s20 offen offset:3072
    s_add_u32 s20, s20, 4096
    buffer_load_dwordx4 a[64:67], v1, s[4:7], s20 offen offset:0
    buffer_load_dwordx4 a[68:71], v1, s[4:7], s20 offen offset:1024
    buffer_load_dwordx4 a[72:75], v1, s[4:7], s20 offen offset:2048
    buffer_load_dwordx4 a[76:79], v1, s[4:7], s20 offen offset:3072
    s_add_u32 s20, s20, 4096
    buffer_load_dwordx4 a[80:83], v1, s[4:7], s20 offen offset:0
    buffer_load_dwordx4 a[84:87], v1, s[4:7], s20 offen offset:1024
    buffer_load_dwordx4 a[88:91], v1, s[4:7], s20 offen offset:2048
    buffer_load_dwordx4 a[92:95], v1, s[4:7], s20 offen offset:3072
    s_add_u32 s20, s20, 4096
    buffer_load_dwordx4 a[96:99], v1, s[4:7], s21 offen offset:0
    buffer_load_dwordx4 a[100:103], v1, s[4:7], s21 offen offset:1024
    buffer_load_dwordx4 a[104:107], v1, s[4:7], s21 offen offset:2048
    buffer_load_dwordx4 a[108:111], v1, s[4:7], s21 offen offset:3072
    s_add_u32 s21, s21, 4096
    buffer_load_dwordx4 a[112:115], v1, s[4:7], s21 offen offset:0
    buffer_load_dwordx4 a[116:119], v1, s[4:7], s21 offen offset:1024
    buffer_load_dwordx4 a[120:123], v1, s[4:7], s21 offen offset:2048
    buffer_load_dwordx4 a[124:127], v1, s[4:7], s21 offen offset:3072
    s_add_u32 s21, s21, 4096
    buffer_load_dwordx4 a[128:131], v1, s[4:7], s21 offen offset:0
    buffer_load_dwordx4 a[132:135], v1, s[4:7], s21 offen offset:1024
    buffer_load_dwordx4 a[136:139], v1, s[4:7], s21 offen offset:2048
    buffer_load_dwordx4 a[140:143], v1, s[4:7], s21 offen offset:3072
    s_add_u32 s21, s21, 4096
    buffer_load_dwordx4 a[144:147], v1, s[4:7], s21 offen offset:0
    buffer_load_dwordx4 a[148:151], v1, s[4:7], s21 offen offset:1024
    buffer_load_dwordx4 a[152:155], v1, s[4:7], s21 offen offset:2048
    buffer_load_dwordx4 a[156:159], v1, s[4:7], s21 offen offset:3072
    s_add_u32 s21, s21, 4096
    buffer_load_dwordx4 a[160:163], v1, s[4:7], s21 offen offset:0
    buffer_load_dwordx4 a[164:167], v1, s[4:7], s21 offen offset:1024
    buffer_load_dwordx4 a[168:171], v1, s[4:7], s21 offen offset:2048
    buffer_load_dwordx4 a[172:175], v1, s[4:7], s21 offen offset:3072
    s_add_u32 s21, s21, 4096
    buffer_load_dwordx4 a[176:179], v1, s[4:7], s21 offen offset:0
    buffer_load_dwordx4 a[180:183], v1, s[4:7], s21 offen offset:1024
    buffer_load_dwordx4 a[184:187], v1, s[4:7], s21 offen offset:2048
    buffer_load_dwordx4 a[188:191], v1, s[4:7], s21 offen offset:3072
    s_add_u32 s21, s21, 4096
    buffer_load_dwordx4 a[192:195], v1, s[4:7], s21 offen offset:0
    buffer_load_dwordx4 a[196:199], v1, s[4:7], s21 offen offset:1024
    buffer_load_dwordx4 a[200:203], v1, s[4:7], s21 offen offset:2048
    buffer_load_dwordx4 a[204:207], v1, s[4:7], s21 offen offset:3072
    s_add_u32 s21, s21, 4096
    buffer_load_dwordx4 a[208:211], v1, s[4:7], s21 offen offset:0
    buffer_load_dwordx4 a[212:215], v1, s[4:7], s21 offen offset:1024
    buffer_load_dwordx4 a[216:219], v1, s[4:7], s21 offen offset:2048
    buffer_load_dwordx4 a[220:223], v1, s[4:7], s21 offen offset:3072
    s_add_u32 s21, s21, 4096
    buffer_load_dwordx4 a[224:227], v1, s[4:7], s21 offen offset:0
    buffer_load_dwordx4 a[228:231], v1, s[4:7], s21 offen offset:1024
    buffer_load_dwordx4 a[232:235], v1, s[4:7], s21 offen offset:2048
    buffer_load_dwordx4 a[236:239], v1, s[4:7], s21 offen offset:3072
    s_add_u32 s21, s21, 4096
    buffer_load_dwordx4 a[240:243], v1, s[4:7], s21 offen offset:0
    buffer_load_dwordx4 a[244:247], v1, s[4:7], s21 offen offset:1024
    buffer_load_dwordx4 a[248:251], v1, s[4:7], s21 offen offset:2048
    buffer_load_dwordx4 a[252:255], v1, s[4:7], s21 offen offset:3072
    s_add_u32 s21, s21, 4096
    s_mov_b32 s26, 0
    s_mul_i32 s27, s22, 40960
    s_mul_i32 s28, s3, 10240
    s_add_u32 s27, s27, s28
    s_add_u32 s27, s27, 35651584
    s_add_u32 s28, s28, s26
    s_mov_b32 m0, s28
    s_add_u32 s28, s28, 4096
    buffer_load_dwordx4 v1, s[4:7], s27 offen offset:0 lds
    buffer_load_dwordx4 v1, s[4:7], s27 offen offset:1024 lds
    buffer_load_dwordx4 v1, s[4:7], s27 offen offset:2048 lds
    buffer_load_dwordx4 v1, s[4:7], s27 offen offset:3072 lds
    s_add_u32 s27, s27, 4096
    s_mov_b32 m0, s28
    s_add_u32 s28, s28, 4096
    buffer_load_dwordx4 v1, s[4:7], s27 offen offset:0 lds
    buffer_load_dwordx4 v1, s[4:7], s27 offen offset:1024 lds
    buffer_load_dwordx4 v1, s[4:7], s27 offen offset:2048 lds
    buffer_load_dwordx4 v1, s[4:7], s27 offen offset:3072 lds
    s_add_u32 s27, s27, 4096
    s_mov_b32 m0, s28
    s_add_u32 s28, s28, 4096
    buffer_load_dwordx4 v1, s[4:7], s27 offen offset:0 lds
    buffer_load_dwordx4 v1, s[4:7], s27 offen offset:1024 lds
    s_waitcnt vmcnt(0)
g1f_loop:
    s_waitcnt vmcnt(2)
    s_barrier
    v_add_u32 v2, s26, v1
    s_xor_b32 s26, s26, 40960
    s_add_u32 s29, s22, s23
    s_cmp_ge_u32 s29, 64
    s_cbranch_scc1 g1f_nodma
    s_mul_i32 s27, s29, 40960
    s_mul_i32 s28, s3, 10240
    s_add_u32 s27, s27, s28
    s_add_u32 s27, s27, 35651584
    s_add_u32 s28, s28, s26
    s_mov_b32 m0, s28
    s_add_u32 s28, s28, 4096
    buffer_load_dwordx4 v1, s[4:7], s27 offen offset:0 lds
    buffer_load_dwordx4 v1, s[4:7], s27 offen offset:1024 lds
    buffer_load_dwordx4 v1, s[4:7], s27 offen offset:2048 lds
    buffer_load_dwordx4 v1, s[4:7], s27 offen offset:3072 lds
    s_add_u32 s27, s27, 4096
    s_mov_b32 m0, s28
    s_add_u32 s28, s28, 4096
    buffer_load_dwordx4 v1, s[4:7], s27 offen offset:0 lds
    buffer_load_dwordx4 v1, s[4:7], s27 offen offset:1024 lds
    buffer_load_dwordx4 v1, s[4:7], s27 offen offset:2048 lds
    buffer_load_dwordx4 v1, s[4:7], s27 offen offset:3072 lds
    s_add_u32 s27, s27, 4096
    s_mov_b32 m0, s28
    s_add_u32 s28, s28, 4096
    buffer_load_dwordx4 v1, s[4:7], s27 offen offset:0 lds
    buffer_load_dwordx4 v1, s[4:7], s27 offen offset:1024 lds
g1f_nodma:
    ds_read_b128 v[48:51], v2 offset:0
    ds_read_b128 v[52:55], v2 offset:20480
    ds_read_b128 v[56:59], v2 offset:1024
    ds_read_b128 v[60:63], v2 offset:21504
    s_waitcnt lgkmcnt(2)
    v_mfma_f32_16x16x32_bf16 v[16:19], v[192:195], v[48:51], 0
    v_mfma_f32_16x16x32_bf16 v[20:23], v[192:195], v[52:55], 0
    v_mfma_f32_16x16x32_bf16 v[24:27], a[16:19], v[48:51], 0
    v_mfma_f32_16x16x32_bf16 v[28:31], a[16:19], v[52:55], 0
    v_mfma_f32_16x16x32_bf16 v[32:35], a[96:99], v[48:51], 0
    v_mfma_f32_16x16x32_bf16 v[36:39], a[96:99], v[52:55], 0
    v_mfma_f32_16x16x32_bf16 v[40:43], a[176:179], v[48:51], 0
    v_mfma_f32_16x16x32_bf16 v[44:47], a[176:179], v[52:55], 0
    ds_read_b128 v[48:51], v2 offset:2048
    ds_read_b128 v[52:55], v2 offset:22528
    s_waitcnt lgkmcnt(2)
    v_mfma_f32_16x16x32_bf16 v[16:19], v[196:199], v[56:59], v[16:19]
    v_mfma_f32_16x16x32_bf16 v[20:23], v[196:199], v[60:63], v[20:23]
    v_mfma_f32_16x16x32_bf16 v[24:27], a[20:23], v[56:59], v[24:27]
    v_mfma_f32_16x16x32_bf16 v[28:31], a[20:23], v[60:63], v[28:31]
    v_mfma_f32_16x16x32_bf16 v[32:35], a[100:103], v[56:59], v[32:35]
    v_mfma_f32_16x16x32_bf16 v[36:39], a[100:103], v[60:63], v[36:39]
    v_mfma_f32_16x16x32_bf16 v[40:43], a[180:183], v[56:59], v[40:43]
    v_mfma_f32_16x16x32_bf16 v[44:47], a[180:183], v[60:63], v[44:47]
    ds_read_b128 v[56:59], v2 offset:3072
    ds_read_b128 v[60:63], v2 offset:23552
    s_waitcnt lgkmcnt(2)
    v_mfma_f32_16x16x32_bf16 v[16:19], v[200:203], v[48:51], v[16:19]
    v_mfma_f32_16x16x32_bf16 v[20:23], v[200:203], v[52:55], v[20:23]
    v_mfma_f32_16x16x32_bf16 v[24:27], a[24:27], v[48:51], v[24:27]
    v_mfma_f32_16x16x32_bf16 v[28:31], a[24:27], v[52:55], v[28:31]
    v_mfma_f32_16x16x32_bf16 v[32:35], a[104:107], v[48:51], v[32:35]
    v_mfma_f32_16x16x32_bf16 v[36:39], a[104:107], v[52:55], v[36:39]
    v_mfma_f32_16x16x32_bf16 v[40:43], a[184:187], v[48:51], v[40:43]
    v_mfma_f32_16x16x32_bf16 v[44:47], a[184:187], v[52:55], v[44:47]
    ds_read_b128 v[48:51], v2 offset:4096
    ds_read_b128 v[52:55], v2 offset:24576
    s_waitcnt lgkmcnt(2)
    v_mfma_f32_16x16x32_bf16 v[16:19], v[204:207], v[56:59], v[16:19]
    v_mfma_f32_16x16x32_bf16 v[20:23], v[204:207], v[60:63], v[20:23]
    v_mfma_f32_16x16x32_bf16 v[24:27], a[28:31], v[56:59], v[24:27]
    v_mfma_f32_16x16x32_bf16 v[28:31], a[28:31], v[60:63], v[28:31]
    v_mfma_f32_16x16x32_bf16 v[32:35], a[108:111], v[56:59], v[32:35]
    v_mfma_f32_16x16x32_bf16 v[36:39], a[108:111], v[60:63], v[36:39]
    v_mfma_f32_16x16x32_bf16 v[40:43], a[188:191], v[56:59], v[40:43]
    v_mfma_f32_16x16x32_bf16 v[44:47], a[188:191], v[60:63], v[44:47]
    ds_read_b128 v[56:59], v2 offset:5120
    ds_read_b128 v[60:63], v2 offset:25600
    s_waitcnt lgkmcnt(2)
    v_mfma_f32_16x16x32_bf16 v[16:19], v[208:211], v[48:51], v[16:19]
    v_mfma_f32_16x16x32_bf16 v[20:23], v[208:211], v[52:55], v[20:23]
    v_mfma_f32_16x16x32_bf16 v[24:27], a[32:35], v[48:51], v[24:27]
    v_mfma_f32_16x16x32_bf16 v[28:31], a[32:35], v[52:55], v[28:31]
    v_mfma_f32_16x16x32_bf16 v[32:35], a[112:115], v[48:51], v[32:35]
    v_mfma_f32_16x16x32_bf16 v[36:39], a[112:115], v[52:55], v[36:39]
    v_mfma_f32_16x16x32_bf16 v[40:43], a[192:195], v[48:51], v[40:43]
    v_mfma_f32_16x16x32_bf16 v[44:47], a[192:195], v[52:55], v[44:47]
    ds_read_b128 v[48:51], v2 offset:6144
    ds_read_b128 v[52:55], v2 offset:26624
    s_waitcnt lgkmcnt(2)
    v_mfma_f32_16x16x32_bf16 v[16:19], v[212:215], v[56:59], v[16:19]
    v_mfma_f32_16x16x32_bf16 v[20:23], v[212:215], v[60:63], v[20:23]
    v_mfma_f32_16x16x32_bf16 v[24:27], a[36:39], v[56:59], v[24:27]
    v_mfma_f32_16x16x32_bf16 v[28:31], a[36:39], v[60:63], v[28:31]
    v_mfma_f32_16x16x32_bf16 v[32:35], a[116:119], v[56:59], v[32:35]
    v_mfma_f32_16x16x32_bf16 v[36:39], a[116:119], v[60:63], v[36:39]
    v_mfma_f32_16x16x32_bf16 v[40:43], a[196:199], v[56:59], v[40:43]
    v_mfma_f32_16x16x32_bf16 v[44:47], a[196:199], v[60:63], v[44:47]
    ds_read_b128 v[56:59], v2 offset:7168
    ds_read_b128 v[60:63], v2 offset:27648
    s_waitcnt lgkmcnt(2)
    v_mfma_f32_16x16x32_bf16 v[16:19], v[216:219], v[48:51], v[16:19]
    v_mfma_f32_16x16x32_bf16 v[20:23], v[216:219], v[52:55], v[20:23]
    v_mfma_f32_16x16x32_bf16 v[24:27], a[40:43], v[48:51], v[24:27]
    v_mfma_f32_16x16x32_bf16 v[28:31], a[40:43], v[52:55], v[28:31]
    v_mfma_f32_16x16x32_bf16 v[32:35], a[120:123], v[48:51], v[32:35]
    v_mfma_f32_16x16x32_bf16 v[36:39], a[120:123], v[52:55], v[36:39]
    v_mfma_f32_16x16x32_bf16 v[40:43], a[200:203], v[48:51], v[40:43]
    v_mfma_f32_16x16x32_bf16 v[44:47], a[200:203], v[52:55], v[44:47]
    ds_read_b128 v[48:51], v2 offset:8192
    ds_read_b128 v[52:55], v2 offset:28672
    s_waitcnt lgkmcnt(2)
    v_mfma_f32_16x16x32_bf16 v[16:19], v[220:223], v[56:59], v[16:19]
    v_mfma_f32_16x16x32_bf16 v[20:23], v[220:223], v[60:63], v[20:23]
    v_mfma_f32_16x16x32_bf16 v[24:27], a[44:47], v[56:59], v[24:27]
    v_mfma_f32_16x16x32_bf16 v[28:31], a[44:47], v[60:63], v[28:31]
    v_mfma_f32_16x16x32_bf16 v[32:35], a[124:127], v[56:59], v[32:35]
    v_mfma_f32_16x16x32_bf16 v[36:39], a[124:127], v[60:63], v[36:39]
    v_mfma_f32_16x16x32_bf16 v[40:43], a[204:207], v[56:59], v[40:43]
    v_mfma_f32_16x16x32_bf16 v[44:47], a[204:207], v[60:63], v[44:47]
    ds_read_b128 v[56:59], v2 offset:9216
    ds_read_b128 v[60:63], v2 offset:29696
    s_waitcnt lgkmcnt(2)
    v_mfma_f32_16x16x32_bf16 v[16:19], v[224:227], v[48:51], v[16:19]
    v_mfma_f32_16x16x32_bf16 v[20:23], v[224:227], v[52:55], v[20:23]
    v_mfma_f32_16x16x32_bf16 v[24:27], a[48:51], v[48:51], v[24:27]
    v_mfma_f32_16x16x32_bf16 v[28:31], a[48:51], v[52:55], v[28:31]
    v_mfma_f32_16x16x32_bf16 v[32:35], a[128:131], v[48:51], v[32:35]
    v_mfma_f32_16x16x32_bf16 v[36:39], a[128:131], v[52:55], v[36:39]
    v_mfma_f32_16x16x32_bf16 v[40:43], a[208:211], v[48:51], v[40:43]
    v_mfma_f32_16x16x32_bf16 v[44:47], a[208:211], v[52:55], v[44:47]
    ds_read_b128 v[48:51], v2 offset:10240
    ds_read_b128 v[52:55], v2 offset:30720
    s_waitcnt lgkmcnt(2)
    v_mfma_f32_16x16x32_bf16 v[16:19], v[228:231], v[56:59], v[16:19]
    v_mfma_f32_16x16x32_bf16 v[20:23], v[228:231], v[60:63], v[20:23]
    v_mfma_f32_16x16x32_bf16 v[24:27], a[52:55], v[56:59], v[24:27]
    v_mfma_f32_16x16x32_bf16 v[28:31], a[52:55], v[60:63], v[28:31]
    v_mfma_f32_16x16x32_bf16 v[32:35], a[132:135], v[56:59], v[32:35]
    v_mfma_f32_16x16x32_bf16 v[36:39], a[132:135], v[60:63], v[36:39]
    v_mfma_f32_16x16x32_bf16 v[40:43], a[212:215], v[56:59], v[40:43]
    v_mfma_f32_16x16x32_bf16 v[44:47], a[212:215], v[60:63], v[44:47]
    ds_read_b128 v[56:59], v2 offset:11264
    ds_read_b128 v[60:63], v2 offset:31744
    s_waitcnt lgkmcnt(2)
    v_mfma_f32_16x16x32_bf16 v[16:19], v[232:235], v[48:51], v[16:19]
    v_mfma_f32_16x16x32_bf16 v[20:23], v[232:235], v[52:55], v[20:23]
    v_mfma_f32_16x16x32_bf16 v[24:27], a[56:59], v[48:51], v[24:27]
    v_mfma_f32_16x16x32_bf16 v[28:31], a[56:59], v[52:55], v[28:31]
    v_mfma_f32_16x16x32_bf16 v[32:35], a[136:139], v[48:51], v[32:35]
    v_mfma_f32_16x16x32_bf16 v[36:39], a[136:139], v[52:55], v[36:39]
    v_mfma_f32_16x16x32_bf16 v[40:43], a[216:219], v[48:51], v[40:43]
    v_mfma_f32_16x16x32_bf16 v[44:47], a[216:219], v[52:55], v[44:47]
    ds_read_b128 v[48:51], v2 offset:12288
    ds_read_b128 v[52:55], v2 offset:32768
    s_waitcnt lgkmcnt(2)
    v_mfma_f32_16x16x32_bf16 v[16:19], v[236:239], v[56:59], v[16:19]
    v_mfma_f32_16x16x32_bf16 v[20:23], v[236:239], v[60:63], v[20:23]
    v_mfma_f32_16x16x32_bf16 v[24:27], a[60:63], v[56:59], v[24:27]
    v_mfma_f32_16x16x32_bf16 v[28:31], a[60:63], v[60:63], v[28:31]
    v_mfma_f32_16x16x32_bf16 v[32:35], a[140:143], v[56:59], v[32:35]
    v_mfma_f32_16x16x32_bf16 v[36:39], a[140:143], v[60:63], v[36:39]
    v_mfma_f32_16x16x32_bf16 v[40:43], a[220:223], v[56:59], v[40:43]
    v_mfma_f32_16x16x32_bf16 v[44:47], a[220:223], v[60:63], v[44:47]
    ds_read_b128 v[56:59], v2 offset:13312
    ds_read_b128 v[60:63], v2 offset:33792
    s_waitcnt lgkmcnt(2)
    v_mfma_f32_16x16x32_bf16 v[16:19], v[240:243], v[48:51], v[16:19]
    v_mfma_f32_16x16x32_bf16 v[20:23], v[240:243], v[52:55], v[20:23]
    v_mfma_f32_16x16x32_bf16 v[24:27], a[64:67], v[48:51], v[24:27]
    v_mfma_f32_16x16x32_bf16 v[28:31], a[64:67], v[52:55], v[28:31]
    v_mfma_f32_16x16x32_bf16 v[32:35], a[144:147], v[48:51], v[32:35]
    v_mfma_f32_16x16x32_bf16 v[36:39], a[144:147], v[52:55], v[36:39]
    v_mfma_f32_16x16x32_bf16 v[40:43], a[224:227], v[48:51], v[40:43]
    v_mfma_f32_16x16x32_bf16 v[44:47], a[224:227], v[52:55], v[44:47]
    ds_read_b128 v[48:51], v2 offset:14336
    ds_read_b128 v[52:55], v2 offset:34816
    s_waitcnt lgkmcnt(2)
    v_mfma_f32_16x16x32_bf16 v[16:19], v[244:247], v[56:59], v[16:19]
    v_mfma_f32_16x16x32_bf16 v[20:23], v[244:247], v[60:63], v[20:23]
    v_mfma_f32_16x16x32_bf16 v[24:27], a[68:71], v[56:59], v[24:27]
    v_mfma_f32_16x16x32_bf16 v[28:31], a[68:71], v[60:63], v[28:31]
    v_mfma_f32_16x16x32_bf16 v[32:35], a[148:151], v[56:59], v[32:35]
    v_mfma_f32_16x16x32_bf16 v[36:39], a[148:151], v[60:63], v[36:39]
    v_mfma_f32_16x16x32_bf16 v[40:43], a[228:231], v[56:59], v[40:43]
    v_mfma_f32_16x16x32_bf16 v[44:47], a[228:231], v[60:63], v[44:47]
    ds_read_b128 v[56:59], v2 offset:15360
    ds_read_b128 v[60:63], v2 offset:35840
    s_waitcnt lgkmcnt(2)
    v_mfma_f32_16x16x32_bf16 v[16:19], v[248:251], v[48:51], v[16:19]
    v_mfma_f32_16x16x32_bf16 v[20:23], v[248:251], v[52:55], v[20:23]
    v_mfma_f32_16x16x32_bf16 v[24:27], a[72:75], v[48:51], v[24:27]
    v_mfma_f32_16x16x32_bf16 v[28:31], a[72:75], v[52:55], v[28:31]
    v_mfma_f32_16x16x32_bf16 v[32:35], a[152:155], v[48:51], v[32:35]
    v_mfma_f32_16x16x32_bf16 v[36:39], a[152:155], v[52:55], v[36:39]
    v_mfma_f32_16x16x32_bf16 v[40:43], a[232:235], v[48:51], v[40:43]
    v_mfma_f32_16x16x32_bf16 v[44:47], a[232:235], v[52:55], v[44:47]
    ds_read_b128 v[48:51], v2 offset:16384
    ds_read_b128 v[52:55], v2 offset:36864
    s_waitcnt lgkmcnt(2)
    v_mfma_f32_16x16x32_bf16 v[16:19], v[252:255], v[56:59], v[16:19]
    v_mfma_f32_16x16x32_bf16 v[20:23], v[252:255], v[60:63], v[20:23]
    v_mfma_f32_16x16x32_bf16 v[24:27], a[76:79], v[56:59], v[24:27]
    v_mfma_f32_16x16x32_bf16 v[28:31], a[76:79], v[60:63], v[28:31]
    v_mfma_f32_16x16x32_bf16 v[32:35], a[156:159], v[56:59], v[32:35]
    v_mfma_f32_16x16x32_bf16 v[36:39], a[156:159], v[60:63], v[36:39]
    v_mfma_f32_16x16x32_bf16 v[40:43], a[236:239], v[56:59], v[40:43]
    v_mfma_f32_16x16x32_bf16 v[44:47], a[236:239], v[60:63], v[44:47]
    ds_read_b128 v[56:59], v2 offset:17408
    ds_read_b128 v[60:63], v2 offset:37888
    s_waitcnt lgkmcnt(2)
    v_mfma_f32_16x16x32_bf16 v[16:19], a[0:3], v[48:51], v[16:19]
    v_mfma_f32_16x16x32_bf16 v[20:23], a[0:3], v[52:55], v[20:23]
    v_mfma_f32_16x16x32_bf16 v[24:27], a[80:83], v[48:51], v[24:27]
    v_mfma_f32_16x16x32_bf16 v[28:31], a[80:83], v[52:55], v[28:31]
    v_mfma_f32_16x16x32_bf16 v[32:35], a[160:163], v[48:51], v[32:35]
    v_mfma_f32_16x16x32_bf16 v[36:39], a[160:163], v[52:55], v[36:39]
    v_mfma_f32_16x16x32_bf16 v[40:43], a[240:243], v[48:51], v[40:43]
    v_mfma_f32_16x16x32_bf16 v[44:47], a[240:243], v[52:55], v[44:47]
    ds_read_b128 v[48:51], v2 offset:18432
    ds_read_b128 v[52:55], v2 offset:38912
    s_waitcnt lgkmcnt(2)
    v_mfma_f32_16x16x32_bf16 v[16:19], a[4:7], v[56:59], v[16:19]
    v_mfma_f32_16x16x32_bf16 v[20:23], a[4:7], v[60:63], v[20:23]
    v_mfma_f32_16x16x32_bf16 v[24:27], a[84:87], v[56:59], v[24:27]
    v_mfma_f32_16x16x32_bf16 v[28:31], a[84:87], v[60:63], v[28:31]
    v_mfma_f32_16x16x32_bf16 v[32:35], a[164:167], v[56:59], v[32:35]
    v_mfma_f32_16x16x32_bf16 v[36:39], a[164:167], v[60:63], v[36:39]
    v_mfma_f32_16x16x32_bf16 v[40:43], a[244:247], v[56:59], v[40:43]
    v_mfma_f32_16x16x32_bf16 v[44:47], a[244:247], v[60:63], v[44:47]
    ds_read_b128 v[56:59], v2 offset:19456
    ds_read_b128 v[60:63], v2 offset:39936
    s_waitcnt lgkmcnt(2)
    v_mfma_f32_16x16x32_bf16 v[16:19], a[8:11], v[48:51], v[16:19]
    v_mfma_f32_16x16x32_bf16 v[20:23], a[8:11], v[52:55], v[20:23]
    v_mfma_f32_16x16x32_bf16 v[24:27], a[88:91], v[48:51], v[24:27]
    v_mfma_f32_16x16x32_bf16 v[28:31], a[88:91], v[52:55], v[28:31]
    v_mfma_f32_16x16x32_bf16 v[32:35], a[168:171], v[48:51], v[32:35]
    v_mfma_f32_16x16x32_bf16 v[36:39], a[168:171], v[52:55], v[36:39]
    v_mfma_f32_16x16x32_bf16 v[40:43], a[248:251], v[48:51], v[40:43]
    v_mfma_f32_16x16x32_bf16 v[44:47], a[248:251], v[52:55], v[44:47]
    s_waitcnt lgkmcnt(0)
    v_mfma_f32_16x16x32_bf16 v[16:19], a[12:15], v[56:59], v[16:19]
    v_mfma_f32_16x16x32_bf16 v[20:23], a[12:15], v[60:63], v[20:23]
    v_mfma_f32_16x16x32_bf16 v[24:27], a[92:95], v[56:59], v[24:27]
    v_mfma_f32_16x16x32_bf16 v[28:31], a[92:95], v[60:63], v[28:31]
    v_mfma_f32_16x16x32_bf16 v[32:35], a[172:175], v[56:59], v[32:35]
    v_mfma_f32_16x16x32_bf16 v[36:39], a[172:175], v[60:63], v[36:39]
    v_mfma_f32_16x16x32_bf16 v[40:43], a[252:255], v[56:59], v[40:43]
    v_mfma_f32_16x16x32_bf16 v[44:47], a[252:255], v[60:63], v[44:47]
    s_mul_i32 s27, s22, s25
    s_add_u32 s27, s27, s24
    s_nop 6
    s_mov_b32 s30, 0xc0135761
    s_mov_b32 s31, 0xbdd2d3e8
    v_mul_f32 v3, v16, v16
    v_mov_b32 v4, s30
    v_mul_f32 v32, v32, v16
    v_fmac_f32 v4, s31, v3
    v_mul_f32 v4, v4, v16
    v_exp_f32 v4, v4
    s_nop 0
    v_add_f32 v4, 1.0, v4
    v_rcp_f32 v4, v4
    s_nop 0
    v_mul_f32 v16, v32, v4
    v_mul_f32 v3, v17, v17
    v_mov_b32 v4, s30
    v_mul_f32 v33, v33, v17
    v_fmac_f32 v4, s31, v3
    v_mul_f32 v4, v4, v17
    v_exp_f32 v4, v4
    s_nop 0
    v_add_f32 v4, 1.0, v4
    v_rcp_f32 v4, v4
    s_nop 0
    v_mul_f32 v17, v33, v4
    v_mul_f32 v3, v18, v18
    v_mov_b32 v4, s30
    v_mul_f32 v34, v34, v18
    v_fmac_f32 v4, s31, v3
    v_mul_f32 v4, v4, v18
    v_exp_f32 v4, v4
    s_nop 0
    v_add_f32 v4, 1.0, v4
    v_rcp_f32 v4, v4
    s_nop 0
    v_mul_f32 v18, v34, v4
    v_mul_f32 v3, v19, v19
    v_mov_b32 v4, s30
    v_mul_f32 v35, v35, v19
    v_fmac_f32 v4, s31, v3
    v_mul_f32 v4, v4, v19
    v_exp_f32 v4, v4
    s_nop 0
    v_add_f32 v4, 1.0, v4
    v_rcp_f32 v4, v4
    s_nop 0
    v_mul_f32 v19, v35, v4
    v_mul_f32 v3, v24, v24
    v_mov_b32 v4, s30
    v_mul_f32 v40, v40, v24
    v_fmac_f32 v4, s31, v3
    v_mul_f32 v4, v4, v24
    v_exp_f32 v4, v4
    s_nop 0
    v_add_f32 v4, 1.0, v4
    v_rcp_f32 v4, v4
    s_nop 0
    v_mul_f32 v24, v40, v4
    v_mul_f32 v3, v25, v25
    v_mov_b32 v4, s30
    v_mul_f32 v41, v41, v25
    v_fmac_f32 v4, s31, v3
    v_mul_f32 v4, v4, v25
    v_exp_f32 v4, v4
    s_nop 0
    v_add_f32 v4, 1.0, v4
    v_rcp_f32 v4, v4
    s_nop 0
    v_mul_f32 v25, v41, v4
    v_mul_f32 v3, v26, v26
    v_mov_b32 v4, s30
    v_mul_f32 v42, v42, v26
    v_fmac_f32 v4, s31, v3
    v_mul_f32 v4, v4, v26
    v_exp_f32 v4, v4
    s_nop 0
    v_add_f32 v4, 1.0, v4
    v_rcp_f32 v4, v4
    s_nop 0
    v_mul_f32 v26, v42, v4
    v_mul_f32 v3, v27, v27
    v_mov_b32 v4, s30
    v_mul_f32 v43, v43, v27
    v_fmac_f32 v4, s31, v3
    v_mul_f32 v4, v4, v27
    v_exp_f32 v4, v4
    s_nop 0
    v_add_f32 v4, 1.0, v4
    v_rcp_f32 v4, v4
    s_nop 0
    v_mul_f32 v27, v43, v4
    v_cvt_pk_bf16_f32 v64, v16, v17
    v_cvt_pk_bf16_f32 v65, v18, v19
    v_cvt_pk_bf16_f32 v66, v24, v25
    v_cvt_pk_bf16_f32 v67, v26, v27
    buffer_store_dwordx4 v[64:67], v1, s[4:7], s27 offen sc1 nt
    s_add_u32 s27, s27, 55296
    v_mul_f32 v3, v20, v20
    v_mov_b32 v4, s30
    v_mul_f32 v36, v36, v20
    v_fmac_f32 v4, s31, v3
    v_mul_f32 v4, v4, v20
    v_exp_f32 v4, v4
    s_nop 0
    v_add_f32 v4, 1.0, v4
    v_rcp_f32 v4, v4
    s_nop 0
    v_mul_f32 v20, v36, v4
    v_mul_f32 v3, v21, v21
    v_mov_b32 v4, s30
    v_mul_f32 v37, v37, v21
    v_fmac_f32 v4, s31, v3
    v_mul_f32 v4, v4, v21
    v_exp_f32 v4, v4
    s_nop 0
    v_add_f32 v4, 1.0, v4
    v_rcp_f32 v4, v4
    s_nop 0
    v_mul_f32 v21, v37, v4
    v_mul_f32 v3, v22, v22
    v_mov_b32 v4, s30
    v_mul_f32 v38, v38, v22
    v_fmac_f32 v4, s31, v3
    v_mul_f32 v4, v4, v22
    v_exp_f32 v4, v4
    s_nop 0
    v_add_f32 v4, 1.0, v4
    v_rcp_f32 v4, v4
    s_nop 0
    v_mul_f32 v22, v38, v4
    v_mul_f32 v3, v23, v23
    v_mov_b32 v4, s30
    v_mul_f32 v39, v39, v23
    v_fmac_f32 v4, s31, v3
    v_mul_f32 v4, v4, v23
    v_exp_f32 v4, v4
    s_nop 0
    v_add_f32 v4, 1.0, v4
    v_rcp_f32 v4, v4
    s_nop 0
    v_mul_f32 v23, v39, v4
    v_mul_f32 v3, v28, v28
    v_mov_b32 v4, s30
    v_mul_f32 v44, v44, v28
    v_fmac_f32 v4, s31, v3
    v_mul_f32 v4, v4, v28
    v_exp_f32 v4, v4
    s_nop 0
    v_add_f32 v4, 1.0, v4
    v_rcp_f32 v4, v4
    s_nop 0
    v_mul_f32 v28, v44, v4
    v_mul_f32 v3, v29, v29
    v_mov_b32 v4, s30
    v_mul_f32 v45, v45, v29
    v_fmac_f32 v4, s31, v3
    v_mul_f32 v4, v4, v29
    v_exp_f32 v4, v4
    s_nop 0
    v_add_f32 v4, 1.0, v4
    v_rcp_f32 v4, v4
    s_nop 0
    v_mul_f32 v29, v45, v4
    v_mul_f32 v3, v30, v30
    v_mov_b32 v4, s30
    v_mul_f32 v46, v46, v30
    v_fmac_f32 v4, s31, v3
    v_mul_f32 v4, v4, v30
    v_exp_f32 v4, v4
    s_nop 0
    v_add_f32 v4, 1.0, v4
    v_rcp_f32 v4, v4
    s_nop 0
    v_mul_f32 v30, v46, v4
    v_mul_f32 v3, v31, v31
    v_mov_b32 v4, s30
    v_mul_f32 v47, v47, v31
    v_fmac_f32 v4, s31, v3
    v_mul_f32 v4, v4, v31
    v_exp_f32 v4, v4
    s_nop 0
    v_add_f32 v4, 1.0, v4
    v_rcp_f32 v4, v4
    s_nop 0
    v_mul_f32 v31, v47, v4
    v_cvt_pk_bf16_f32 v68, v20, v21
    v_cvt_pk_bf16_f32 v69, v22, v23
    v_cvt_pk_bf16_f32 v70, v28, v29
    v_cvt_pk_bf16_f32 v71, v30, v31
    buffer_store_dwordx4 v[68:71], v1, s[4:7], s27 offen sc1 nt
    s_add_u32 s27, s27, 55296
    s_mov_b32 s22, s29
    s_cmp_lt_u32 s22, 64
    s_cbranch_scc1 g1f_loop
g1_end:
    s_mov_b32 s12, 47136768
    s_waitcnt vmcnt(0)
    s_mov_b64 exec, 1
    v_mov_b32 v5, 1
    buffer_atomic_add v5, off, s[4:7], s12 sc1
    s_mov_b64 exec, -1
w_ph2:
    v_lshrrev_b32 v1, 4, v1
    s_cmp_ge_u32 s41, 28
    s_cbranch_scc1 w_end
    s_cmp_ge_u32 s41, 20
    s_cbranch_scc1 w_attn
    s_load_dwordx2 s[8:9], s[0:1], 0
    s_mov_b32 s10, 2621440
    s_mov_b32 s11, 0x00020000
    s_load_dwordx2 s[12:13], s[0:1], 88
    s_mov_b32 s14, 2621440
    s_mov_b32 s15, 0x00020000
    s_mov_b32 s20, s41
    s_mov_b32 s22, s40
    s_mov_b32 s23, 7
    s_waitcnt lgkmcnt(0)
    v_and_b32 v2, 15, v1
    v_lshrrev_b32 v3, 4, v1
    v_lshlrev_b32 v2, 7, v2
    v_lshl_add_u32 v2, v3, 4, v2
    s_lshl_b32 s24, s3, 12
    v_add_u32 v2, s24, v2
    v_lshlrev_b32 v3, 4, v0
    v_lshrrev_b32 v4, 3, v0
    v_and_b32 v5, 7, v0
    v_mul_u32_u24 v4, 1280, v4
    v_lshl_add_u32 v4, v5, 3, v4
    s_lshl_b32 s24, s20, 6
    v_add_u32 v4, s24, v4
    v_lshlrev_b32 v1, 4, v1
    s_mul_i32 s25, s3, 13
    s_min_u32 s26, s3, 1
    s_add_u32 s25, s25, s26
    s_lshl_b32 s25, s25, 10
    s_lshl_b32 s26, s3, 15
    s_mov_b32 s30, 47136768
    s_cmp_lg_u32 s3, 0
    s_cbranch_scc1 out_all_b
out_all:
    s_sub_u32 s50, s50, 1
    s_cbranch_scc1 w_end
    buffer_load_dword v5, off, s[4:7], s30 sc1
    s_waitcnt vmcnt(0)
    v_cmp_ne_u32 vcc, 871, v5
    s_cbranch_vccnz out_all
out_all_b:
    s_barrier
    s_mul_i32 s27, s20, 262144
    s_add_u32 s27, s27, s26
    s_add_u32 s27, s27, 27262976
    s_mul_i32 s28, s20, 110592
    s_add_u32 s28, s28, s25
    s_add_u32 s28, s28, 32505856
    buffer_load_dwordx4 a[0:3], v1, s[4:7], s27 offen offset:0
    buffer_load_dwordx4 a[8:11], v1, s[4:7], s27 offen offset:1024
    buffer_load_dwordx4 a[16:19], v1, s[4:7], s27 offen offset:2048
    buffer_load_dwordx4 a[24:27], v1, s[4:7], s27 offen offset:3072
    s_add_u32 s27, s27, 4096
    buffer_load_dwordx4 a[32:35], v1, s[4:7], s27 offen offset:0
    buffer_load_dwordx4 a[40:43], v1, s[4:7], s27 offen offset:1024
    buffer_load_dwordx4 a[48:51], v1, s[4:7], s27 offen offset:2048
    buffer_load_dwordx4 a[56:59], v1, s[4:7], s27 offen offset:3072
    s_add_u32 s27, s27, 4096
    buffer_load_dwordx4 a[64:67], v1, s[4:7], s27 offen offset:0
    buffer_load_dwordx4 a[72:75], v1, s[4:7], s27 offen offset:1024
    buffer_load_dwordx4 a[80:83], v1, s[4:7], s27 offen offset:2048
    buffer_load_dwordx4 a[88:91], v1, s[4:7], s27 offen offset:3072
    s_add_u32 s27, s27, 4096
    buffer_load_dwordx4 a[96:99], v1, s[4:7], s27 offen offset:0
    buffer_load_dwordx4 a[104:107], v1, s[4:7], s27 offen offset:1024
    buffer_load_dwordx4 a[112:115], v1, s[4:7], s27 offen offset:2048
    buffer_load_dwordx4 a[120:123], v1, s[4:7], s27 offen offset:3072
    s_add_u32 s27, s27, 4096
    buffer_load_dwordx4 a[128:131], v1, s[4:7], s27 offen offset:0
    buffer_load_dwordx4 a[136:139], v1, s[4:7], s27 offen offset:1024
    buffer_load_dwordx4 a[144:147], v1, s[4:7], s27 offen offset:2048
    buffer_load_dwordx4 a[152:155], v1, s[4:7], s27 offen offset:3072
    s_add_u32 s27, s27, 4096
    buffer_load_dwordx4 a[160:163], v1, s[4:7], s27 offen offset:0
    buffer_load_dwordx4 a[168:171], v1, s[4:7], s27 offen offset:1024
    buffer_load_dwordx4 a[176:179], v1, s[4:7], s27 offen offset:2048
    buffer_load_dwordx4 a[184:187], v1, s[4:7], s27 offen offset:3072
    s_add_u32 s27, s27, 4096
    buffer_load_dwordx4 a[192:195], v1, s[4:7], s27 offen offset:0
    buffer_load_dwordx4 a[200:203], v1, s[4:7], s27 offen offset:1024
    buffer_load_dwordx4 a[208:211], v1, s[4:7], s27 offen offset:2048
    buffer_load_dwordx4 a[216:219], v1, s[4:7], s27 offen offset:3072
    s_add_u32 s27, s27, 4096
    buffer_load_dwordx4 a[224:227], v1, s[4:7], s27 offen offset:0
    buffer_load_dwordx4 a[232:235], v1, s[4:7], s27 offen offset:1024
    buffer_load_dwordx4 a[240:243], v1, s[4:7], s27 offen offset:2048
    buffer_load_dwordx4 a[248:251], v1, s[4:7], s27 offen offset:3072
    s_add_u32 s27, s27, 4096
    buffer_load_dwordx4 v[144:147], v1, s[4:7], s28 offen offset:0
    buffer_load_dwordx4 v[152:155], v1, s[4:7], s28 offen offset:1024
    buffer_load_dwordx4 v[160:163], v1, s[4:7], s28 offen offset:2048
    buffer_load_dwordx4 v[168:171], v1, s[4:7], s28 offen offset:3072
    s_add_u32 s28, s28, 4096
    buffer_load_dwordx4 v[176:179], v1, s[4:7], s28 offen offset:0
    buffer_load_dwordx4 v[184:187], v1, s[4:7], s28 offen offset:1024
    buffer_load_dwordx4 v[192:195], v1, s[4:7], s28 offen offset:2048
    buffer_load_dwordx4 v[200:203], v1, s[4:7], s28 offen offset:3072
    s_add_u32 s28, s28, 4096
    buffer_load_dwordx4 v[208:211], v1, s[4:7], s28 offen offset:0
    buffer_load_dwordx4 v[216:219], v1, s[4:7], s28 offen offset:1024
    buffer_load_dwordx4 v[224:227], v1, s[4:7], s28 offen offset:2048
    buffer_load_dwordx4 v[232:235], v1, s[4:7], s28 offen offset:3072
    s_add_u32 s28, s28, 4096
    buffer_load_dwordx4 v[240:243], v1, s[4:7], s28 offen offset:0
    buffer_load_dwordx4 v[248:251], v1, s[4:7], s28 offen offset:1024
    s_mul_i32 s27, s20, 262144
    s_add_u32 s27, s27, s26
    s_add_u32 s27, s27, 27394048
    s_mul_i32 s28, s20, 110592
    s_add_u32 s28, s28, s25
    s_add_u32 s28, s28, 32561152
    buffer_load_dwordx4 a[4:7], v1, s[4:7], s27 offen offset:0
    buffer_load_dwordx4 a[12:15], v1, s[4:7], s27 offen offset:1024
    buffer_load_dwordx4 a[20:23], v1, s[4:7], s27 offen offset:2048
    buffer_load_dwordx4 a[28:31], v1, s[4:7], s27 offen offset:3072
    s_add_u32 s27, s27, 4096
    buffer_load_dwordx4 a[36:39], v1, s[4:7], s27 offen offset:0
    buffer_load_dwordx4 a[44:47], v1, s[4:7], s27 offen offset:1024
    buffer_load_dwordx4 a[52:55], v1, s[4:7], s27 offen offset:2048
    buffer_load_dwordx4 a[60:63], v1, s[4:7], s27 offen offset:3072
    s_add_u32 s27, s27, 4096
    buffer_load_dwordx4 a[68:71], v1, s[4:7], s27 offen offset:0
    buffer_load_dwordx4 a[76:79], v1, s[4:7], s27 offen offset:1024
    buffer_load_dwordx4 a[84:87], v1, s[4:7], s27 offen offset:2048
    buffer_load_dwordx4 a[92:95], v1, s[4:7], s27 offen offset:3072
    s_add_u32 s27, s27, 4096
    buffer_load_dwordx4 a[100:103], v1, s[4:7], s27 offen offset:0
    buffer_load_dwordx4 a[108:111], v1, s[4:7], s27 offen offset:1024
    buffer_load_dwordx4 a[116:119], v1, s[4:7], s27 offen offset:2048
    buffer_load_dwordx4 a[124:127], v1, s[4:7], s27 offen offset:3072
    s_add_u32 s27, s27, 4096
    buffer_load_dwordx4 a[132:135], v1, s[4:7], s27 offen offset:0
    buffer_load_dwordx4 a[140:143], v1, s[4:7], s27 offen offset:1024
    buffer_load_dwordx4 a[148:151], v1, s[4:7], s27 offen offset:2048
    buffer_load_dwordx4 a[156:159], v1, s[4:7], s27 offen offset:3072
    s_add_u32 s27, s27, 4096
    buffer_load_dwordx4 a[164:167], v1, s[4:7], s27 offen offset:0
    buffer_load_dwordx4 a[172:175], v1, s[4:7], s27 offen offset:1024
    buffer_load_dwordx4 a[180:183], v1, s[4:7], s27 offen offset:2048
    buffer_load_dwordx4 a[188:191], v1, s[4:7], s27 offen offset:3072
    s_add_u32 s27, s27, 4096
    buffer_load_dwordx4 a[196:199], v1, s[4:7], s27 offen offset:0
    buffer_load_dwordx4 a[204:207], v1, s[4:7], s27 offen offset:1024
    buffer_load_dwordx4 a[212:215], v1, s[4:7], s27 offen offset:2048
    buffer_load_dwordx4 a[220:223], v1, s[4:7], s27 offen offset:3072
    s_add_u32 s27, s27, 4096
    buffer_load_dwordx4 a[228:231], v1, s[4:7], s27 offen offset:0
    buffer_load_dwordx4 a[236:239], v1, s[4:7], s27 offen offset:1024
    buffer_load_dwordx4 a[244:247], v1, s[4:7], s27 offen offset:2048
    buffer_load_dwordx4 a[252:255], v1, s[4:7], s27 offen offset:3072
    s_add_u32 s27, s27, 4096
    buffer_load_dwordx4 v[148:151], v1, s[4:7], s28 offen offset:0
    buffer_load_dwordx4 v[156:159], v1, s[4:7], s28 offen offset:1024
    buffer_load_dwordx4 v[164:167], v1, s[4:7], s28 offen offset:2048
    buffer_load_dwordx4 v[172:175], v1, s[4:7], s28 offen offset:3072
    s_add_u32 s28, s28, 4096
    buffer_load_dwordx4 v[180:183], v1, s[4:7], s28 offen offset:0
    buffer_load_dwordx4 v[188:191], v1, s[4:7], s28 offen offset:1024
    buffer_load_dwordx4 v[196:199], v1, s[4:7], s28 offen offset:2048
    buffer_load_dwordx4 v[204:207], v1, s[4:7], s28 offen offset:3072
    s_add_u32 s28, s28, 4096
    buffer_load_dwordx4 v[212:215], v1, s[4:7], s28 offen offset:0
    buffer_load_dwordx4 v[220:223], v1, s[4:7], s28 offen offset:1024
    buffer_load_dwordx4 v[228:231], v1, s[4:7], s28 offen offset:2048
    buffer_load_dwordx4 v[236:239], v1, s[4:7], s28 offen offset:3072
    s_add_u32 s28, s28, 4096
    buffer_load_dwordx4 v[244:247], v1, s[4:7], s28 offen offset:0
    buffer_load_dwordx4 v[252:255], v1, s[4:7], s28 offen offset:1024
    s_waitcnt vmcnt(0)
    s_cmp_lt_u32 s3, 2
    s_cbranch_scc1 out_nz
    v_mov_b32 v144, 0
    v_mov_b32 v145, 0
    v_mov_b32 v146, 0
    v_mov_b32 v147, 0
    v_mov_b32 v148, 0
    v_mov_b32 v149, 0
    v_mov_b32 v150, 0
    v_mov_b32 v151, 0
out_nz:
    s_add_u32 s26, s26, 100663296
    s_add_u32 s25, s25, 38797312
    s_mov_b32 s31, 0
    s_lshl_b32 s27, s22, 18
    s_add_u32 s27, s27, s26
    s_mul_i32 s28, s22, 110592
    s_add_u32 s28, s28, s25
    s_add_u32 s30, s28, 0
    buffer_load_dwordx4 v[40:43], v1, s[4:7], s30 offen
    s_add_u32 s30, s28, 55296
    buffer_load_dwordx4 v[44:47], v1, s[4:7], s30 offen
    s_add_u32 s30, s28, 1024
    buffer_load_dwordx4 v[48:51], v1, s[4:7], s30 offen
    s_add_u32 s30, s28, 56320
    buffer_load_dwordx4 v[52:55], v1, s[4:7], s30 offen
    s_add_u32 s30, s28, 2048
    buffer_load_dwordx4 v[56:59], v1, s[4:7], s30 offen
    s_add_u32 s30, s28, 57344
    buffer_load_dwordx4 v[60:63], v1, s[4:7], s30 offen
    s_add_u32 s30, s28, 3072
    buffer_load_dwordx4 v[64:67], v1, s[4:7], s30 offen
    s_add_u32 s30, s28, 58368
    buffer_load_dwordx4 v[68:71], v1, s[4:7], s30 offen
    s_add_u32 s30, s28, 4096
    buffer_load_dwordx4 v[72:75], v1, s[4:7], s30 offen
    s_add_u32 s30, s28, 59392
    buffer_load_dwordx4 v[76:79], v1, s[4:7], s30 offen
    s_add_u32 s30, s28, 5120
    buffer_load_dwordx4 v[80:83], v1, s[4:7], s30 offen
    s_add_u32 s30, s28, 60416
    buffer_load_dwordx4 v[84:87], v1, s[4:7], s30 offen
    s_add_u32 s30, s28, 6144
    buffer_load_dwordx4 v[88:91], v1, s[4:7], s30 offen
    s_add_u32 s30, s28, 61440
    buffer_load_dwordx4 v[92:95], v1, s[4:7], s30 offen
    s_add_u32 s30, s28, 7168
    buffer_load_dwordx4 v[96:99], v1, s[4:7], s30 offen
    s_add_u32 s30, s28, 62464
    buffer_load_dwordx4 v[100:103], v1, s[4:7], s30 offen
    s_add_u32 s30, s28, 8192
    buffer_load_dwordx4 v[104:107], v1, s[4:7], s30 offen
    s_add_u32 s30, s28, 63488
    buffer_load_dwordx4 v[108:111], v1, s[4:7], s30 offen
    s_add_u32 s30, s28, 9216
    buffer_load_dwordx4 v[112:115], v1, s[4:7], s30 offen
    s_add_u32 s30, s28, 64512
    buffer_load_dwordx4 v[116:119], v1, s[4:7], s30 offen
    s_add_u32 s30, s28, 10240
    buffer_load_dwordx4 v[120:123], v1, s[4:7], s30 offen
    s_add_u32 s30, s28, 65536
    buffer_load_dwordx4 v[124:127], v1, s[4:7], s30 offen
    s_add_u32 s30, s28, 11264
    buffer_load_dwordx4 v[128:131], v1, s[4:7], s30 offen
out_loop:
    s_mul_i32 s24, s22, 40960
    s_add_u32 s29, s22, s23
    s_min_u32 s21, s29, 63
    s_waitcnt vmcnt(22)
    v_mfma_f32_16x16x32_bf16 v[16:19], v[144:147], v[40:43], 0
    v_mfma_f32_16x16x32_bf16 v[20:23], v[148:151], v[40:43], 0
    s_add_u32 s30, s28, 66560
    buffer_load_dwordx4 v[40:43], v1, s[4:7], s30 offen
    s_waitcnt vmcnt(22)
    v_mfma_f32_16x16x32_bf16 v[24:27], v[144:147], v[44:47], 0
    v_mfma_f32_16x16x32_bf16 v[28:31], v[148:151], v[44:47], 0
    s_add_u32 s30, s28, 12288
    buffer_load_dwordx4 v[44:47], v1, s[4:7], s30 offen
    s_waitcnt vmcnt(22)
    v_mfma_f32_16x16x32_bf16 v[16:19], v[152:155], v[48:51], v[16:19]
    v_mfma_f32_16x16x32_bf16 v[20:23], v[156:159], v[48:51], v[20:23]
    s_add_u32 s30, s28, 67584
    buffer_load_dwordx4 v[48:51], v1, s[4:7], s30 offen
    s_waitcnt vmcnt(22)
    v_mfma_f32_16x16x32_bf16 v[24:27], v[152:155], v[52:55], v[24:27]
    v_mfma_f32_16x16x32_bf16 v[28:31], v[156:159], v[52:55], v[28:31]
    s_add_u32 s30, s28, 13312
    buffer_load_dwordx4 v[52:55], v1, s[4:7], s30 offen
    s_waitcnt vmcnt(22)
    v_mfma_f32_16x16x32_bf16 v[16:19], v[160:163], v[56:59], v[16:19]
    v_mfma_f32_16x16x32_bf16 v[20:23], v[164:167], v[56:59], v[20:23]
    s_add_u32 s30, s28, 68608
    buffer_load_dwordx4 v[56:59], v1, s[4:7], s30 offen
    s_waitcnt vmcnt(22)
    v_mfma_f32_16x16x32_bf16 v[24:27], v[160:163], v[60:63], v[24:27]
    v_mfma_f32_16x16x32_bf16 v[28:31], v[164:167], v[60:63], v[28:31]
    s_lshl_b32 s30, s22, 7
    s_add_u32 s30, s30, 47128576
    s_cmp_lg_u32 s3, 0
    s_cbranch_scc1 out_cnt_b
out_cnt:
    s_sub_u32 s50, s50, 1
    s_cbranch_scc1 w_end
    buffer_load_dword v5, off, s[4:7], s30 sc1
    s_waitcnt vmcnt(0)
    v_cmp_ne_u32 vcc, 31, v5
    s_cbranch_vccnz out_cnt
out_cnt_b:
    s_barrier
    s_add_u32 s30, s27, 0
    buffer_load_dwordx4 v[60:63], v1, s[4:7], s30 offen
    s_waitcnt vmcnt(22)
    v_mfma_f32_16x16x32_bf16 v[16:19], v[168:171], v[64:67], v[16:19]
    v_mfma_f32_16x16x32_bf16 v[20:23], v[172:175], v[64:67], v[20:23]
    s_add_u32 s30, s27, 131072
    buffer_load_dwordx4 v[64:67], v1, s[4:7], s30 offen
    s_waitcnt vmcnt(22)
    v_mfma_f32_16x16x32_bf16 v[24:27], v[168:171], v[68:71], v[24:27]
    v_mfma_f32_16x16x32_bf16 v[28:31], v[172:175], v[68:71], v[28:31]
    s_add_u32 s30, s27, 1024
    buffer_load_dwordx4 v[68:71], v1, s[4:7], s30 offen
    s_waitcnt vmcnt(22)
    v_mfma_f32_16x16x32_bf16 v[16:19], v[176:179], v[72:75], v[16:19]
    v_mfma_f32_16x16x32_bf16 v[20:23], v[180:183], v[72:75], v[20:23]
    s_add_u32 s30, s27, 132096
    buffer_load_dwordx4 v[72:75], v1, s[4:7], s30 offen
    s_waitcnt vmcnt(22)
    v_mfma_f32_16x16x32_bf16 v[24:27], v[176:179], v[76:79], v[24:27]
    v_mfma_f32_16x16x32_bf16 v[28:31], v[180:183], v[76:79], v[28:31]
    s_add_u32 s30, s27, 2048
    buffer_load_dwordx4 v[76:79], v1, s[4:7], s30 offen
    s_waitcnt vmcnt(22)
    v_mfma_f32_16x16x32_bf16 v[16:19], v[184:187], v[80:83], v[16:19]
    v_mfma_f32_16x16x32_bf16 v[20:23], v[188:191], v[80:83], v[20:23]
    s_add_u32 s30, s27, 133120
    buffer_load_dwordx4 v[80:83], v1, s[4:7], s30 offen
    s_waitcnt vmcnt(22)
    v_mfma_f32_16x16x32_bf16 v[24:27], v[184:187], v[84:87], v[24:27]
    v_mfma_f32_16x16x32_bf16 v[28:31], v[188:191], v[84:87], v[28:31]
    s_add_u32 s30, s27, 3072
    buffer_load_dwordx4 v[84:87], v1, s[4:7], s30 offen
    s_waitcnt vmcnt(22)
    v_mfma_f32_16x16x32_bf16 v[16:19], v[192:195], v[88:91], v[16:19]
    v_mfma_f32_16x16x32_bf16 v[20:23], v[196:199], v[88:91], v[20:23]
    s_add_u32 s30, s27, 134144
    buffer_load_dwordx4 v[88:91], v1, s[4:7], s30 offen
    s_waitcnt vmcnt(22)
    v_mfma_f32_16x16x32_bf16 v[24:27], v[192:195], v[92:95], v[24:27]
    v_mfma_f32_16x16x32_bf16 v[28:31], v[196:199], v[92:95], v[28:31]
    s_add_u32 s30, s27, 4096
    buffer_load_dwordx4 v[92:95], v1, s[4:7], s30 offen
    s_waitcnt vmcnt(22)
    v_mfma_f32_16x16x32_bf16 v[16:19], v[200:203], v[96:99], v[16:19]
    v_mfma_f32_16x16x32_bf16 v[20:23], v[204:207], v[96:99], v[20:23]
    s_add_u32 s30, s27, 135168
    buffer_load_dwordx4 v[96:99], v1, s[4:7], s30 offen
    s_waitcnt vmcnt(22)
    v_mfma_f32_16x16x32_bf16 v[24:27], v[200:203], v[100:103], v[24:27]
    v_mfma_f32_16x16x32_bf16 v[28:31], v[204:207], v[100:103], v[28:31]
    s_add_u32 s30, s27, 5120
    buffer_load_dwordx4 v[100:103], v1, s[4:7], s30 offen
    s_waitcnt vmcnt(22)
    v_mfma_f32_16x16x32_bf16 v[16:19], v[208:211], v[104:107], v[16:19]
    v_mfma_f32_16x16x32_bf16 v[20:23], v[212:215], v[104:107], v[20:23]
    s_add_u32 s30, s27, 136192
    buffer_load_dwordx4 v[104:107], v1, s[4:7], s30 offen
    s_waitcnt vmcnt(22)
    v_mfma_f32_16x16x32_bf16 v[24:27], v[208:211], v[108:111], v[24:27]
    v_mfma_f32_16x16x32_bf16 v[28:31], v[212:215], v[108:111], v[28:31]
    s_add_u32 s30, s27, 6144
    buffer_load_dwordx4 v[108:111], v1, s[4:7], s30 offen
    s_waitcnt vmcnt(22)
    v_mfma_f32_16x16x32_bf16 v[16:19], v[216:219], v[112:115], v[16:19]
    v_mfma_f32_16x16x32_bf16 v[20:23], v[220:223], v[112:115], v[20:23]
    s_add_u32 s30, s27, 137216
    buffer_load_dwordx4 v[112:115], v1, s[4:7], s30 offen
    s_waitcnt vmcnt(22)
    v_mfma_f32_16x16x32_bf16 v[24:27], v[216:219], v[116:119], v[24:27]
    v_mfma_f32_16x16x32_bf16 v[28:31], v[220:223], v[116:119], v[28:31]
    s_add_u32 s30, s27, 7168
    buffer_load_dwordx4 v[116:119], v1, s[4:7], s30 offen
    s_waitcnt vmcnt(22)
    v_mfma_f32_16x16x32_bf16 v[16:19], v[224:227], v[120:123], v[16:19]
    v_mfma_f32_16x16x32_bf16 v[20:23], v[228:231], v[120:123], v[20:23]
    s_add_u32 s30, s27, 138240
    buffer_load_dwordx4 v[120:123], v1, s[4:7], s30 offen
    s_waitcnt vmcnt(22)
    v_mfma_f32_16x16x32_bf16 v[24:27], v[224:227], v[124:127], v[24:27]
    v_mfma_f32_16x16x32_bf16 v[28:31], v[228:231], v[124:127], v[28:31]
    s_add_u32 s30, s27, 8192
    buffer_load_dwordx4 v[124:127], v1, s[4:7], s30 offen
    s_waitcnt vmcnt(22)
    v_mfma_f32_16x16x32_bf16 v[16:19], v[232:235], v[128:131], v[16:19]
    v_mfma_f32_16x16x32_bf16 v[20:23], v[236:239], v[128:131], v[20:23]
    s_add_u32 s30, s27, 139264
    buffer_load_dwordx4 v[128:131], v1, s[4:7], s30 offen
    s_waitcnt vmcnt(22)
    v_mfma_f32_16x16x32_bf16 v[24:27], v[232:235], v[40:43], v[24:27]
    v_mfma_f32_16x16x32_bf16 v[28:31], v[236:239], v[40:43], v[28:31]
    s_add_u32 s30, s27, 9216
    buffer_load_dwordx4 v[40:43], v1, s[4:7], s30 offen
    s_waitcnt vmcnt(22)
    v_mfma_f32_16x16x32_bf16 v[16:19], v[240:243], v[44:47], v[16:19]
    v_mfma_f32_16x16x32_bf16 v[20:23], v[244:247], v[44:47], v[20:23]
    s_add_u32 s30, s27, 140288
    buffer_load_dwordx4 v[44:47], v1, s[4:7], s30 offen
    s_waitcnt vmcnt(22)
    v_mfma_f32_16x16x32_bf16 v[24:27], v[240:243], v[48:51], v[24:27]
    v_mfma_f32_16x16x32_bf16 v[28:31], v[244:247], v[48:51], v[28:31]
    s_add_u32 s30, s27, 10240
    buffer_load_dwordx4 v[48:51], v1, s[4:7], s30 offen
    s_waitcnt vmcnt(22)
    v_mfma_f32_16x16x32_bf16 v[16:19], v[248:251], v[52:55], v[16:19]
    v_mfma_f32_16x16x32_bf16 v[20:23], v[252:255], v[52:55], v[20:23]
    s_add_u32 s30, s27, 141312
    buffer_load_dwordx4 v[52:55], v1, s[4:7], s30 offen
    s_waitcnt vmcnt(22)
    v_mfma_f32_16x16x32_bf16 v[24:27], v[248:251], v[56:59], v[24:27]
    v_mfma_f32_16x16x32_bf16 v[28:31], v[252:255], v[56:59], v[28:31]
    s_add_u32 s30, s27, 11264
    buffer_load_dwordx4 v[56:59], v1, s[4:7], s30 offen
    s_waitcnt vmcnt(22)
    v_mfma_f32_16x16x32_bf16 v[16:19], a[0:3], v[60:63], v[16:19]
    v_mfma_f32_16x16x32_bf16 v[20:23], a[4:7], v[60:63], v[20:23]
    s_add_u32 s30, s27, 142336
    buffer_load_dwordx4 v[60:63], v1, s[4:7], s30 offen
    s_waitcnt vmcnt(22)
    v_mfma_f32_16x16x32_bf16 v[24:27], a[0:3], v[64:67], v[24:27]
    v_mfma_f32_16x16x32_bf16 v[28:31], a[4:7], v[64:67], v[28:31]
    s_add_u32 s30, s27, 12288
    buffer_load_dwordx4 v[64:67], v1, s[4:7], s30 offen
    s_waitcnt vmcnt(22)
    v_mfma_f32_16x16x32_bf16 v[16:19], a[8:11], v[68:71], v[16:19]
    v_mfma_f32_16x16x32_bf16 v[20:23], a[12:15], v[68:71], v[20:23]
    s_add_u32 s30, s27, 143360
    buffer_load_dwordx4 v[68:71], v1, s[4:7], s30 offen
    s_waitcnt vmcnt(22)
    v_mfma_f32_16x16x32_bf16 v[24:27], a[8:11], v[72:75], v[24:27]
    v_mfma_f32_16x16x32_bf16 v[28:31], a[12:15], v[72:75], v[28:31]
    s_add_u32 s30, s27, 13312
    buffer_load_dwordx4 v[72:75], v1, s[4:7], s30 offen
    s_waitcnt vmcnt(22)
    v_mfma_f32_16x16x32_bf16 v[16:19], a[16:19], v[76:79], v[16:19]
    v_mfma_f32_16x16x32_bf16 v[20:23], a[20:23], v[76:79], v[20:23]
    s_add_u32 s30, s27, 144384
    buffer_load_dwordx4 v[76:79], v1, s[4:7], s30 offen
    s_waitcnt vmcnt(22)
    v_mfma_f32_16x16x32_bf16 v[24:27], a[16:19], v[80:83], v[24:27]
    v_mfma_f32_16x16x32_bf16 v[28:31], a[20:23], v[80:83], v[28:31]
    s_add_u32 s30, s27, 14336
    buffer_load_dwordx4 v[80:83], v1, s[4:7], s30 offen
    s_waitcnt vmcnt(22)
    v_mfma_f32_16x16x32_bf16 v[16:19], a[24:27], v[84:87], v[16:19]
    v_mfma_f32_16x16x32_bf16 v[20:23], a[28:31], v[84:87], v[20:23]
    s_add_u32 s30, s27, 145408
    buffer_load_dwordx4 v[84:87], v1, s[4:7], s30 offen
    s_waitcnt vmcnt(22)
    v_mfma_f32_16x16x32_bf16 v[24:27], a[24:27], v[88:91], v[24:27]
    v_mfma_f32_16x16x32_bf16 v[28:31], a[28:31], v[88:91], v[28:31]
    s_add_u32 s30, s27, 15360
    buffer_load_dwordx4 v[88:91], v1, s[4:7], s30 offen
    s_waitcnt vmcnt(22)
    v_mfma_f32_16x16x32_bf16 v[16:19], a[32:35], v[92:95], v[16:19]
    v_mfma_f32_16x16x32_bf16 v[20:23], a[36:39], v[92:95], v[20:23]
    s_add_u32 s30, s27, 146432
    buffer_load_dwordx4 v[92:95], v1, s[4:7], s30 offen
    s_waitcnt vmcnt(22)
    v_mfma_f32_16x16x32_bf16 v[24:27], a[32:35], v[96:99], v[24:27]
    v_mfma_f32_16x16x32_bf16 v[28:31], a[36:39], v[96:99], v[28:31]
    s_add_u32 s30, s27, 16384
    buffer_load_dwordx4 v[96:99], v1, s[4:7], s30 offen
    s_waitcnt vmcnt(22)
    v_mfma_f32_16x16x32_bf16 v[16:19], a[40:43], v[100:103], v[16:19]
    v_mfma_f32_16x16x32_bf16 v[20:23], a[44:47], v[100:103], v[20:23]
    s_add_u32 s30, s27, 147456
    buffer_load_dwordx4 v[100:103], v1, s[4:7], s30 offen
    s_waitcnt vmcnt(22)
    v_mfma_f32_16x16x32_bf16 v[24:27], a[40:43], v[104:107], v[24:27]
    v_mfma_f32_16x16x32_bf16 v[28:31], a[44:47], v[104:107], v[28:31]
    s_add_u32 s30, s27, 17408
    buffer_load_dwordx4 v[104:107], v1, s[4:7], s30 offen
    s_waitcnt vmcnt(22)
    v_mfma_f32_16x16x32_bf16 v[16:19], a[48:51], v[108:111], v[16:19]
    v_mfma_f32_16x16x32_bf16 v[20:23], a[52:55], v[108:111], v[20:23]
    s_add_u32 s30, s27, 148480
    buffer_load_dwordx4 v[108:111], v1, s[4:7], s30 offen
    buffer_load_dwordx2 v[6:7], v4, s[8:11], s24 offen
    s_waitcnt vmcnt(23)
    v_mfma_f32_16x16x32_bf16 v[24:27], a[48:51], v[112:115], v[24:27]
    v_mfma_f32_16x16x32_bf16 v[28:31], a[52:55], v[112:115], v[28:31]
    s_add_u32 s30, s27, 18432
    buffer_load_dwordx4 v[112:115], v1, s[4:7], s30 offen
    s_waitcnt vmcnt(23)
    v_mfma_f32_16x16x32_bf16 v[16:19], a[56:59], v[116:119], v[16:19]
    v_mfma_f32_16x16x32_bf16 v[20:23], a[60:63], v[116:119], v[20:23]
    s_add_u32 s30, s27, 149504
    buffer_load_dwordx4 v[116:119], v1, s[4:7], s30 offen
    s_waitcnt vmcnt(23)
    v_mfma_f32_16x16x32_bf16 v[24:27], a[56:59], v[120:123], v[24:27]
    v_mfma_f32_16x16x32_bf16 v[28:31], a[60:63], v[120:123], v[28:31]
    s_add_u32 s30, s27, 19456
    buffer_load_dwordx4 v[120:123], v1, s[4:7], s30 offen
    s_waitcnt vmcnt(23)
    v_mfma_f32_16x16x32_bf16 v[16:19], a[64:67], v[124:127], v[16:19]
    v_mfma_f32_16x16x32_bf16 v[20:23], a[68:71], v[124:127], v[20:23]
    s_add_u32 s30, s27, 150528
    buffer_load_dwordx4 v[124:127], v1, s[4:7], s30 offen
    s_waitcnt vmcnt(23)
    v_mfma_f32_16x16x32_bf16 v[24:27], a[64:67], v[128:131], v[24:27]
    v_mfma_f32_16x16x32_bf16 v[28:31], a[68:71], v[128:131], v[28:31]
    s_add_u32 s30, s27, 20480
    buffer_load_dwordx4 v[128:131], v1, s[4:7], s30 offen
    s_waitcnt vmcnt(23)
    v_mfma_f32_16x16x32_bf16 v[16:19], a[72:75], v[40:43], v[16:19]
    v_mfma_f32_16x16x32_bf16 v[20:23], a[76:79], v[40:43], v[20:23]
    s_add_u32 s30, s27, 151552
    buffer_load_dwordx4 v[40:43], v1, s[4:7], s30 offen
    s_waitcnt vmcnt(23)
    v_mfma_f32_16x16x32_bf16 v[24:27], a[72:75], v[44:47], v[24:27]
    v_mfma_f32_16x16x32_bf16 v[28:31], a[76:79], v[44:47], v[28:31]
    s_add_u32 s30, s27, 21504
    buffer_load_dwordx4 v[44:47], v1, s[4:7], s30 offen
    s_waitcnt vmcnt(23)
    v_mfma_f32_16x16x32_bf16 v[16:19], a[80:83], v[48:51], v[16:19]
    v_mfma_f32_16x16x32_bf16 v[20:23], a[84:87], v[48:51], v[20:23]
    s_add_u32 s30, s27, 152576
    buffer_load_dwordx4 v[48:51], v1, s[4:7], s30 offen
    s_waitcnt vmcnt(23)
    v_mfma_f32_16x16x32_bf16 v[24:27], a[80:83], v[52:55], v[24:27]
    v_mfma_f32_16x16x32_bf16 v[28:31], a[84:87], v[52:55], v[28:31]
    s_add_u32 s30, s27, 22528
    buffer_load_dwordx4 v[52:55], v1, s[4:7], s30 offen
    s_waitcnt vmcnt(23)
    v_mfma_f32_16x16x32_bf16 v[16:19], a[88:91], v[56:59], v[16:19]
    v_mfma_f32_16x16x32_bf16 v[20:23], a[92:95], v[56:59], v[20:23]
    s_add_u32 s30, s27, 153600
    buffer_load_dwordx4 v[56:59], v1, s[4:7], s30 offen
    s_waitcnt vmcnt(23)
    v_mfma_f32_16x16x32_bf16 v[24:27], a[88:91], v[60:63], v[24:27]
    v_mfma_f32_16x16x32_bf16 v[28:31], a[92:95], v[60:63], v[28:31]
    s_add_u32 s30, s27, 23552
    buffer_load_dwordx4 v[60:63], v1, s[4:7], s30 offen
    s_waitcnt vmcnt(23)
    v_mfma_f32_16x16x32_bf16 v[16:19], a[96:99], v[64:67], v[16:19]
    v_mfma_f32_16x16x32_bf16 v[20:23], a[100:103], v[64:67], v[20:23]
    s_add_u32 s30, s27, 154624
    buffer_load_dwordx4 v[64:67], v1, s[4:7], s30 offen
    s_waitcnt vmcnt(23)
    v_mfma_f32_16x16x32_bf16 v[24:27], a[96:99], v[68:71], v[24:27]
    v_mfma_f32_16x16x32_bf16 v[28:31], a[100:103], v[68:71], v[28:31]
    s_add_u32 s30, s27, 24576
    buffer_load_dwordx4 v[68:71], v1, s[4:7], s30 offen
    s_waitcnt vmcnt(23)
    v_mfma_f32_16x16x32_bf16 v[16:19], a[104:107], v[72:75], v[16:19]
    v_mfma_f32_16x16x32_bf16 v[20:23], a[108:111], v[72:75], v[20:23]
    s_add_u32 s30, s27, 155648
    buffer_load_dwordx4 v[72:75], v1, s[4:7], s30 offen
    s_waitcnt vmcnt(23)
    v_mfma_f32_16x16x32_bf16 v[24:27], a[104:107], v[76:79], v[24:27]
    v_mfma_f32_16x16x32_bf16 v[28:31], a[108:111], v[76:79], v[28:31]
    s_add_u32 s30, s27, 25600
    buffer_load_dwordx4 v[76:79], v1, s[4:7], s30 offen
    s_waitcnt vmcnt(23)
    v_mfma_f32_16x16x32_bf16 v[16:19], a[112:115], v[80:83], v[16:19]
    v_mfma_f32_16x16x32_bf16 v[20:23], a[116:119], v[80:83], v[20:23]
    s_add_u32 s30, s27, 156672
    buffer_load_dwordx4 v[80:83], v1, s[4:7], s30 offen
    s_waitcnt vmcnt(23)
    v_mfma_f32_16x16x32_bf16 v[24:27], a[112:115], v[84:87], v[24:27]
    v_mfma_f32_16x16x32_bf16 v[28:31], a[116:119], v[84:87], v[28:31]
    s_add_u32 s30, s27, 26624
    buffer_load_dwordx4 v[84:87], v1, s[4:7], s30 offen
    s_waitcnt vmcnt(23)
    v_mfma_f32_16x16x32_bf16 v[16:19], a[120:123], v[88:91], v[16:19]
    v_mfma_f32_16x16x32_bf16 v[20:23], a[124:127], v[88:91], v[20:23]
    s_add_u32 s30, s27, 157696
    buffer_load_dwordx4 v[88:91], v1, s[4:7], s30 offen
    s_waitcnt vmcnt(23)
    v_mfma_f32_16x16x32_bf16 v[24:27], a[120:123], v[92:95], v[24:27]
    v_mfma_f32_16x16x32_bf16 v[28:31], a[124:127], v[92:95], v[28:31]
    s_add_u32 s30, s27, 27648
    buffer_load_dwordx4 v[92:95], v1, s[4:7], s30 offen
    s_waitcnt vmcnt(23)
    v_mfma_f32_16x16x32_bf16 v[16:19], a[128:131], v[96:99], v[16:19]
    v_mfma_f32_16x16x32_bf16 v[20:23], a[132:135], v[96:99], v[20:23]
    s_add_u32 s30, s27, 158720
    buffer_load_dwordx4 v[96:99], v1, s[4:7], s30 offen
    s_waitcnt vmcnt(23)
    v_mfma_f32_16x16x32_bf16 v[24:27], a[128:131], v[100:103], v[24:27]
    v_mfma_f32_16x16x32_bf16 v[28:31], a[132:135], v[100:103], v[28:31]
    s_add_u32 s30, s27, 28672
    buffer_load_dwordx4 v[100:103], v1, s[4:7], s30 offen
    s_waitcnt vmcnt(23)
    v_mfma_f32_16x16x32_bf16 v[16:19], a[136:139], v[104:107], v[16:19]
    v_mfma_f32_16x16x32_bf16 v[20:23], a[140:143], v[104:107], v[20:23]
    s_add_u32 s30, s27, 159744
    buffer_load_dwordx4 v[104:107], v1, s[4:7], s30 offen
    s_waitcnt vmcnt(23)
    v_mfma_f32_16x16x32_bf16 v[24:27], a[136:139], v[108:111], v[24:27]
    v_mfma_f32_16x16x32_bf16 v[28:31], a[140:143], v[108:111], v[28:31]
    s_add_u32 s30, s27, 29696
    buffer_load_dwordx4 v[108:111], v1, s[4:7], s30 offen
    s_waitcnt vmcnt(22)
    v_mfma_f32_16x16x32_bf16 v[16:19], a[144:147], v[112:115], v[16:19]
    v_mfma_f32_16x16x32_bf16 v[20:23], a[148:151], v[112:115], v[20:23]
    s_add_u32 s30, s27, 160768
    buffer_load_dwordx4 v[112:115], v1, s[4:7], s30 offen
    s_waitcnt vmcnt(22)
    v_mfma_f32_16x16x32_bf16 v[24:27], a[144:147], v[116:119], v[24:27]
    v_mfma_f32_16x16x32_bf16 v[28:31], a[148:151], v[116:119], v[28:31]
    s_add_u32 s30, s27, 30720
    buffer_load_dwordx4 v[116:119], v1, s[4:7], s30 offen
    s_waitcnt vmcnt(22)
    v_mfma_f32_16x16x32_bf16 v[16:19], a[152:155], v[120:123], v[16:19]
    v_mfma_f32_16x16x32_bf16 v[20:23], a[156:159], v[120:123], v[20:23]
    s_add_u32 s30, s27, 161792
    buffer_load_dwordx4 v[120:123], v1, s[4:7], s30 offen
    s_waitcnt vmcnt(22)
    v_mfma_f32_16x16x32_bf16 v[24:27], a[152:155], v[124:127], v[24:27]
    v_mfma_f32_16x16x32_bf16 v[28:31], a[156:159], v[124:127], v[28:31]
    s_add_u32 s30, s27, 31744
    buffer_load_dwordx4 v[124:127], v1, s[4:7], s30 offen
    s_waitcnt vmcnt(22)
    v_mfma_f32_16x16x32_bf16 v[16:19], a[160:163], v[128:131], v[16:19]
    v_mfma_f32_16x16x32_bf16 v[20:23], a[164:167], v[128:131], v[20:23]
    s_add_u32 s30, s27, 162816
    buffer_load_dwordx4 v[128:131], v1, s[4:7], s30 offen
    s_waitcnt vmcnt(22)
    v_mfma_f32_16x16x32_bf16 v[24:27], a[160:163], v[40:43], v[24:27]
    v_mfma_f32_16x16x32_bf16 v[28:31], a[164:167], v[40:43], v[28:31]
    s_lshl_b32 s27, s21, 18
    s_add_u32 s27, s27, s26
    s_mul_i32 s28, s21, 110592
    s_add_u32 s28, s28, s25
    s_add_u32 s30, s28, 0
    buffer_load_dwordx4 v[40:43], v1, s[4:7], s30 offen
    s_waitcnt vmcnt(22)
    v_mfma_f32_16x16x32_bf16 v[16:19], a[168:171], v[44:47], v[16:19]
    v_mfma_f32_16x16x32_bf16 v[20:23], a[172:175], v[44:47], v[20:23]
    s_add_u32 s30, s28, 55296
    buffer_load_dwordx4 v[44:47], v1, s[4:7], s30 offen
    s_waitcnt vmcnt(22)
    v_mfma_f32_16x16x32_bf16 v[24:27], a[168:171], v[48:51], v[24:27]
    v_mfma_f32_16x16x32_bf16 v[28:31], a[172:175], v[48:51], v[28:31]
    s_add_u32 s30, s28, 1024
    buffer_load_dwordx4 v[48:51], v1, s[4:7], s30 offen
    s_waitcnt vmcnt(22)
    v_mfma_f32_16x16x32_bf16 v[16:19], a[176:179], v[52:55], v[16:19]
    v_mfma_f32_16x16x32_bf16 v[20:23], a[180:183], v[52:55], v[20:23]
    s_add_u32 s30, s28, 56320
    buffer_load_dwordx4 v[52:55], v1, s[4:7], s30 offen
    s_waitcnt vmcnt(22)
    v_mfma_f32_16x16x32_bf16 v[24:27], a[176:179], v[56:59], v[24:27]
    v_mfma_f32_16x16x32_bf16 v[28:31], a[180:183], v[56:59], v[28:31]
    s_add_u32 s30, s28, 2048
    buffer_load_dwordx4 v[56:59], v1, s[4:7], s30 offen
    s_waitcnt vmcnt(22)
    v_mfma_f32_16x16x32_bf16 v[16:19], a[184:187], v[60:63], v[16:19]
    v_mfma_f32_16x16x32_bf16 v[20:23], a[188:191], v[60:63], v[20:23]
    s_add_u32 s30, s28, 57344
    buffer_load_dwordx4 v[60:63], v1, s[4:7], s30 offen
    s_waitcnt vmcnt(22)
    v_mfma_f32_16x16x32_bf16 v[24:27], a[184:187], v[64:67], v[24:27]
    v_mfma_f32_16x16x32_bf16 v[28:31], a[188:191], v[64:67], v[28:31]
    s_add_u32 s30, s28, 3072
    buffer_load_dwordx4 v[64:67], v1, s[4:7], s30 offen
    s_waitcnt vmcnt(22)
    v_mfma_f32_16x16x32_bf16 v[16:19], a[192:195], v[68:71], v[16:19]
    v_mfma_f32_16x16x32_bf16 v[20:23], a[196:199], v[68:71], v[20:23]
    s_add_u32 s30, s28, 58368
    buffer_load_dwordx4 v[68:71], v1, s[4:7], s30 offen
    s_waitcnt vmcnt(22)
    v_mfma_f32_16x16x32_bf16 v[24:27], a[192:195], v[72:75], v[24:27]
    v_mfma_f32_16x16x32_bf16 v[28:31], a[196:199], v[72:75], v[28:31]
    s_add_u32 s30, s28, 4096
    buffer_load_dwordx4 v[72:75], v1, s[4:7], s30 offen
    s_waitcnt vmcnt(22)
    v_mfma_f32_16x16x32_bf16 v[16:19], a[200:203], v[76:79], v[16:19]
    v_mfma_f32_16x16x32_bf16 v[20:23], a[204:207], v[76:79], v[20:23]
    s_add_u32 s30, s28, 59392
    buffer_load_dwordx4 v[76:79], v1, s[4:7], s30 offen
    s_waitcnt vmcnt(22)
    v_mfma_f32_16x16x32_bf16 v[24:27], a[200:203], v[80:83], v[24:27]
    v_mfma_f32_16x16x32_bf16 v[28:31], a[204:207], v[80:83], v[28:31]
    s_add_u32 s30, s28, 5120
    buffer_load_dwordx4 v[80:83], v1, s[4:7], s30 offen
    s_waitcnt vmcnt(22)
    v_mfma_f32_16x16x32_bf16 v[16:19], a[208:211], v[84:87], v[16:19]
    v_mfma_f32_16x16x32_bf16 v[20:23], a[212:215], v[84:87], v[20:23]
    s_add_u32 s30, s28, 60416
    buffer_load_dwordx4 v[84:87], v1, s[4:7], s30 offen
    s_waitcnt vmcnt(22)
    v_mfma_f32_16x16x32_bf16 v[24:27], a[208:211], v[88:91], v[24:27]
    v_mfma_f32_16x16x32_bf16 v[28:31], a[212:215], v[88:91], v[28:31]
    s_add_u32 s30, s28, 6144
    buffer_load_dwordx4 v[88:91], v1, s[4:7], s30 offen
    s_waitcnt vmcnt(22)
    v_mfma_f32_16x16x32_bf16 v[16:19], a[216:219], v[92:95], v[16:19]
    v_mfma_f32_16x16x32_bf16 v[20:23], a[220:223], v[92:95], v[20:23]
    s_add_u32 s30, s28, 61440
    buffer_load_dwordx4 v[92:95], v1, s[4:7], s30 offen
    s_waitcnt vmcnt(22)
    v_mfma_f32_16x16x32_bf16 v[24:27], a[216:219], v[96:99], v[24:27]
    v_mfma_f32_16x16x32_bf16 v[28:31], a[220:223], v[96:99], v[28:31]
    s_add_u32 s30, s28, 7168
    buffer_load_dwordx4 v[96:99], v1, s[4:7], s30 offen
    s_waitcnt vmcnt(22)
    v_mfma_f32_16x16x32_bf16 v[16:19], a[224:227], v[100:103], v[16:19]
    v_mfma_f32_16x16x32_bf16 v[20:23], a[228:231], v[100:103], v[20:23]
    s_add_u32 s30, s28, 62464
    buffer_load_dwordx4 v[100:103], v1, s[4:7], s30 offen
    s_waitcnt vmcnt(22)
    v_mfma_f32_16x16x32_bf16 v[24:27], a[224:227], v[104:107], v[24:27]
    v_mfma_f32_16x16x32_bf16 v[28:31], a[228:231], v[104:107], v[28:31]
    s_add_u32 s30, s28, 8192
    buffer_load_dwordx4 v[104:107], v1, s[4:7], s30 offen
    s_waitcnt vmcnt(22)
    v_mfma_f32_16x16x32_bf16 v[16:19], a[232:235], v[108:111], v[16:19]
    v_mfma_f32_16x16x32_bf16 v[20:23], a[236:239], v[108:111], v[20:23]
    s_add_u32 s30, s28, 63488
    buffer_load_dwordx4 v[108:111], v1, s[4:7], s30 offen
    s_waitcnt vmcnt(22)
    v_mfma_f32_16x16x32_bf16 v[24:27], a[232:235], v[112:115], v[24:27]
    v_mfma_f32_16x16x32_bf16 v[28:31], a[236:239], v[112:115], v[28:31]
    s_add_u32 s30, s28, 9216
    buffer_load_dwordx4 v[112:115], v1, s[4:7], s30 offen
    s_waitcnt vmcnt(22)
    v_mfma_f32_16x16x32_bf16 v[16:19], a[240:243], v[116:119], v[16:19]
    v_mfma_f32_16x16x32_bf16 v[20:23], a[244:247], v[116:119], v[20:23]
    s_add_u32 s30, s28, 64512
    buffer_load_dwordx4 v[116:119], v1, s[4:7], s30 offen
    s_waitcnt vmcnt(22)
    v_mfma_f32_16x16x32_bf16 v[24:27], a[240:243], v[120:123], v[24:27]
    v_mfma_f32_16x16x32_bf16 v[28:31], a[244:247], v[120:123], v[28:31]
    s_add_u32 s30, s28, 10240
    buffer_load_dwordx4 v[120:123], v1, s[4:7], s30 offen
    s_waitcnt vmcnt(22)
    v_mfma_f32_16x16x32_bf16 v[16:19], a[248:251], v[124:127], v[16:19]
    v_mfma_f32_16x16x32_bf16 v[20:23], a[252:255], v[124:127], v[20:23]
    s_add_u32 s30, s28, 65536
    buffer_load_dwordx4 v[124:127], v1, s[4:7], s30 offen
    s_waitcnt vmcnt(22)
    v_mfma_f32_16x16x32_bf16 v[24:27], a[248:251], v[128:131], v[24:27]
    v_mfma_f32_16x16x32_bf16 v[28:31], a[252:255], v[128:131], v[28:31]
    s_add_u32 s30, s28, 11264
    buffer_load_dwordx4 v[128:131], v1, s[4:7], s30 offen
    v_add_u32 v8, s31, v2
    v_add_u32 v9, s31, v3
    s_xor_b32 s31, s31, 16384
    s_nop 3
    ds_write_b128 v8, v[16:19] offset:0
    ds_write_b128 v8, v[20:23] offset:64
    ds_write_b128 v8, v[24:27] offset:2048
    ds_write_b128 v8, v[28:31] offset:2112
    s_waitcnt lgkmcnt(0)
    s_barrier
    ds_read_b128 v[16:19], v9 offset:0
    ds_read_b128 v[20:23], v9 offset:4096
    ds_read_b128 v[24:27], v9 offset:8192
    ds_read_b128 v[28:31], v9 offset:12288
    v_lshlrev_b32 v10, 16, v6
    v_and_b32 v11, 0xffff0000, v6
    v_lshlrev_b32 v12, 16, v7
    v_and_b32 v13, 0xffff0000, v7
    s_waitcnt lgkmcnt(0)
    v_add_f32 v10, v10, v16
    v_add_f32 v11, v11, v17
    v_add_f32 v12, v12, v18
    v_add_f32 v13, v13, v19
    v_add_f32 v10, v10, v20
    v_add_f32 v11, v11, v21
    v_add_f32 v12, v12, v22
    v_add_f32 v13, v13, v23
    v_add_f32 v10, v10, v24
    v_add_f32 v11, v11, v25
    v_add_f32 v12, v12, v26
    v_add_f32 v13, v13, v27
    v_add_f32 v10, v10, v28
    v_add_f32 v11, v11, v29
    v_add_f32 v12, v12, v30
    v_add_f32 v13, v13, v31
    v_cvt_pk_bf16_f32 v10, v10, v11
    v_cvt_pk_bf16_f32 v11, v12, v13
    s_waitcnt vmcnt(0)
    buffer_store_dwordx2 v[10:11], v4, s[12:15], s24 offen
    s_mov_b32 s22, s29
    s_cmp_lt_u32 s22, 64
    s_cbranch_scc1 out_loop
    s_endpgm
w_attn:
    v_and_b32 v2, 15, v1
    v_lshrrev_b32 v3, 4, v1
    v_lshlrev_b32 v3, 2, v3
    v_sub_u32 v2, v2, v3
    v_cmp_gt_i32 s[32:33], 0, v2
    v_cmp_gt_i32 s[34:35], 1, v2
    v_cmp_gt_i32 s[36:37], 2, v2
    v_cmp_gt_i32 s[38:39], 3, v2
    v_lshlrev_b32 v1, 4, v1
    v_mov_b32 v2, 0xf149f2ca
    s_mov_b32 s30, 0x3e0293ee
    s_sub_u32 s41, s41, 20
    s_lshl_b32 s41, s41, 2
    s_add_u32 s41, s41, s3
    s_lshl_b32 s42, s41, 7
    s_add_u32 s42, s42, 47124480
    s_mov_b32 s12, 47136768
    s_cmp_lg_u32 s3, 0
    s_cbranch_scc1 attn_all_b
attn_all:
    s_sub_u32 s50, s50, 1
    s_cbranch_scc1 w_end
    buffer_load_dword v5, off, s[4:7], s12 sc1
    s_waitcnt vmcnt(0)
    v_cmp_ne_u32 vcc, 871, v5
    s_cbranch_vccnz attn_all
attn_all_b:
    s_barrier
attn_loop:
    s_lshl_b32 s20, s40, 5
    s_add_u32 s20, s20, s41
    s_mul_i32 s23, s41, 65
    s_add_u32 s23, s23, s40
    s_lshl_b32 s21, s23, 14
    s_add_u32 s21, s21, 167772160
    s_lshl_b32 s22, s20, 13
    s_lshl_b32 s23, s23, 13
    s_add_u32 s23, s23, 209715200
    s_add_u32 s22, s22, 83886080
    buffer_load_dwordx4 v[80:83], v1, s[4:7], s22 offen offset:0
    buffer_load_dwordx4 v[84:87], v1, s[4:7], s22 offen offset:1024
    buffer_load_dwordx4 v[88:91], v1, s[4:7], s22 offen offset:2048
    buffer_load_dwordx4 v[92:95], v1, s[4:7], s22 offen offset:3072
    s_add_u32 s22, s22, 4096
    buffer_load_dwordx4 v[96:99], v1, s[4:7], s22 offen offset:0
    buffer_load_dwordx4 v[100:103], v1, s[4:7], s22 offen offset:1024
    buffer_load_dwordx4 v[104:107], v1, s[4:7], s22 offen offset:2048
    buffer_load_dwordx4 v[108:111], v1, s[4:7], s22 offen offset:3072
    s_add_u32 s22, s22, 4096
    buffer_load_dwordx4 v[16:19], v1, s[4:7], s21 offen offset:0
    buffer_load_dwordx4 v[20:23], v1, s[4:7], s21 offen offset:1024
    buffer_load_dwordx4 v[24:27], v1, s[4:7], s21 offen offset:2048
    buffer_load_dwordx4 v[28:31], v1, s[4:7], s21 offen offset:3072
    s_add_u32 s21, s21, 4096
    buffer_load_dwordx4 v[32:35], v1, s[4:7], s21 offen offset:0
    buffer_load_dwordx4 v[36:39], v1, s[4:7], s21 offen offset:1024
    buffer_load_dwordx4 v[40:43], v1, s[4:7], s21 offen offset:2048
    buffer_load_dwordx4 v[44:47], v1, s[4:7], s21 offen offset:3072
    s_add_u32 s21, s21, 4096
    buffer_load_dwordx4 v[48:51], v1, s[4:7], s21 offen offset:0
    buffer_load_dwordx4 v[52:55], v1, s[4:7], s21 offen offset:1024
    buffer_load_dwordx4 v[56:59], v1, s[4:7], s21 offen offset:2048
    buffer_load_dwordx4 v[60:63], v1, s[4:7], s21 offen offset:3072
    s_add_u32 s21, s21, 4096
    buffer_load_dwordx4 v[64:67], v1, s[4:7], s21 offen offset:0
    buffer_load_dwordx4 v[68:71], v1, s[4:7], s21 offen offset:1024
    buffer_load_dwordx4 v[72:75], v1, s[4:7], s21 offen offset:2048
    buffer_load_dwordx4 v[76:79], v1, s[4:7], s21 offen offset:3072
    s_add_u32 s21, s21, 4096
attn_rec:
    s_sub_u32 s50, s50, 1
    s_cbranch_scc1 w_end
    buffer_load_dwordx4 v[4:7], off, s[4:7], s42 sc1
    s_waitcnt vmcnt(0)
    v_min3_i32 v4, v4, v5, v6
    v_min_i32 v4, v4, v7
    s_nop 1
    v_readfirstlane_b32 s43, v4
    s_sub_i32 s43, s43, 0
    s_cmp_gt_i32 s43, s40
    s_cbranch_scc0 attn_rec
    s_add_u32 s24, s23, 4096
    buffer_load_dwordx4 v[112:115], v1, s[4:7], s23 offen offset:0
    buffer_load_dwordx4 v[116:119], v1, s[4:7], s23 offen offset:1024
    buffer_load_dwordx4 v[120:123], v1, s[4:7], s23 offen offset:2048
    buffer_load_dwordx4 v[124:127], v1, s[4:7], s23 offen offset:3072
    buffer_load_dwordx4 v[128:131], v1, s[4:7], s24 offen offset:0
    buffer_load_dwordx4 v[132:135], v1, s[4:7], s24 offen offset:1024
    buffer_load_dwordx4 v[136:139], v1, s[4:7], s24 offen offset:2048
    buffer_load_dwordx4 v[140:143], v1, s[4:7], s24 offen offset:3072
    s_waitcnt vmcnt(0)
    v_mfma_f32_16x16x32_bf16 v[144:147], v[112:115], v[80:83], 0
    v_mfma_f32_16x16x32_bf16 v[148:151], v[16:19], v[80:83], 0
    v_mfma_f32_16x16x32_bf16 v[152:155], v[112:115], v[84:87], 0
    v_mfma_f32_16x16x32_bf16 v[156:159], v[16:19], v[84:87], 0
    v_mfma_f32_16x16x32_bf16 v[160:163], v[20:23], v[84:87], 0
    v_mfma_f32_16x16x32_bf16 v[144:147], v[120:123], v[88:91], v[144:147]
    v_mfma_f32_16x16x32_bf16 v[148:151], v[32:35], v[88:91], v[148:151]
    v_mfma_f32_16x16x32_bf16 v[152:155], v[120:123], v[92:95], v[152:155]
    v_mfma_f32_16x16x32_bf16 v[156:159], v[32:35], v[92:95], v[156:159]
    v_mfma_f32_16x16x32_bf16 v[160:163], v[36:39], v[92:95], v[160:163]
    v_mfma_f32_16x16x32_bf16 v[144:147], v[128:131], v[96:99], v[144:147]
    v_mfma_f32_16x16x32_bf16 v[148:151], v[48:51], v[96:99], v[148:151]
    v_mfma_f32_16x16x32_bf16 v[152:155], v[128:131], v[100:103], v[152:155]
    v_mfma_f32_16x16x32_bf16 v[156:159], v[48:51], v[100:103], v[156:159]
    v_mfma_f32_16x16x32_bf16 v[160:163], v[52:55], v[100:103], v[160:163]
    v_mfma_f32_16x16x32_bf16 v[144:147], v[136:139], v[104:107], v[144:147]
    v_mfma_f32_16x16x32_bf16 v[148:151], v[64:67], v[104:107], v[148:151]
    v_mfma_f32_16x16x32_bf16 v[152:155], v[136:139], v[108:111], v[152:155]
    v_mfma_f32_16x16x32_bf16 v[156:159], v[64:67], v[108:111], v[156:159]
    v_mfma_f32_16x16x32_bf16 v[160:163], v[68:71], v[108:111], v[160:163]
    s_lshr_b32 s21, s20, 5
    s_and_b32 s22, s20, 31
    s_lshl_b32 s21, s21, 18
    s_lshl_b32 s22, s22, 12
    s_add_u32 s21, s21, s22
    s_add_u32 s21, s21, 100663296
    s_nop 2
    v_cndmask_b32 v148, v148, v2, s[32:33]
    v_cndmask_b32 v149, v149, v2, s[34:35]
    v_cndmask_b32 v150, v150, v2, s[36:37]
    v_cndmask_b32 v151, v151, v2, s[38:39]
    v_max_f32 v4, v144, v145
    v_max3_f32 v4, v4, v146, v147
    v_max3_f32 v4, v4, v148, v149
    v_max3_f32 v4, v4, v150, v151
    v_mov_b32 v5, v4
    s_nop 1
    v_permlane32_swap_b32 v5, v4
    v_max_f32 v4, v4, v5
    v_mov_b32 v5, v4
    s_nop 1
    v_permlane16_swap_b32 v5, v4
    v_max_f32 v4, v4, v5
    v_mul_f32 v5, 0xbe0293ee, v4
    v_fma_f32 v144, v144, s30, v5
    v_fma_f32 v145, v145, s30, v5
    v_fma_f32 v146, v146, s30, v5
    v_fma_f32 v147, v147, s30, v5
    v_fma_f32 v148, v148, s30, v5
    v_fma_f32 v149, v149, s30, v5
    v_fma_f32 v150, v150, s30, v5
    v_fma_f32 v151, v151, s30, v5
    v_exp_f32 v144, v144
    v_exp_f32 v145, v145
    v_exp_f32 v146, v146
    v_exp_f32 v147, v147
    v_exp_f32 v148, v148
    v_exp_f32 v149, v149
    v_exp_f32 v150, v150
    v_exp_f32 v151, v151
    v_mov_b64 v[168:169], 0
    v_cvt_pk_bf16_f32 v164, v144, v145
    v_cvt_pk_bf16_f32 v165, v146, v147
    v_cvt_pk_bf16_f32 v166, v148, v149
    v_cvt_pk_bf16_f32 v167, v150, v151
    v_add_f32 v4, v144, v145
    v_add_f32 v5, v146, v147
    v_add_f32 v4, v4, v5
    v_mul_f32 v4, 0.5, v4
    v_mfma_f32_16x16x32_bf16 v[176:179], v[24:27], v[166:169], 0
    v_mfma_f32_16x16x32_bf16 v[180:183], v[28:31], v[166:169], 0
    v_mfma_f32_16x16x32_bf16 v[184:187], v[40:43], v[166:169], 0
    v_mfma_f32_16x16x32_bf16 v[188:191], v[44:47], v[166:169], 0
    v_mfma_f32_16x16x32_bf16 v[192:195], v[56:59], v[166:169], 0
    v_mfma_f32_16x16x32_bf16 v[196:199], v[60:63], v[166:169], 0
    v_mfma_f32_16x16x32_bf16 v[200:203], v[72:75], v[166:169], 0
    v_mfma_f32_16x16x32_bf16 v[204:207], v[76:79], v[166:169], 0
    v_mfma_f32_16x16x16_bf16 v[176:179], v[116:117], v[164:165], v[176:179]
    v_mfma_f32_16x16x16_bf16 v[180:183], v[118:119], v[164:165], v[180:183]
    v_mfma_f32_16x16x16_bf16 v[184:187], v[124:125], v[164:165], v[184:187]
    v_mfma_f32_16x16x16_bf16 v[188:191], v[126:127], v[164:165], v[188:191]
    v_mfma_f32_16x16x16_bf16 v[192:195], v[132:133], v[164:165], v[192:195]
    v_mfma_f32_16x16x16_bf16 v[196:199], v[134:135], v[164:165], v[196:199]
    v_mfma_f32_16x16x16_bf16 v[200:203], v[140:141], v[164:165], v[200:203]
    v_mfma_f32_16x16x16_bf16 v[204:207], v[142:143], v[164:165], v[204:207]
    v_add_f32 v4, v4, v148
    v_add_f32 v4, v4, v149
    v_add_f32 v4, v4, v150
    v_add_f32 v4, v4, v151
    v_mov_b32 v5, v4
    s_nop 1
    v_permlane32_swap_b32 v5, v4
    v_add_f32 v4, v4, v5
    v_mov_b32 v5, v4
    s_nop 1
    v_permlane16_swap_b32 v5, v4
    v_add_f32 v4, v4, v5
    v_rcp_f32 v4, v4
    s_nop 0
    v_mul_f32 v176, v176, v4
    v_mul_f32 v177, v177, v4
    v_mul_f32 v178, v178, v4
    v_mul_f32 v179, v179, v4
    v_mul_f32 v180, v180, v4
    v_mul_f32 v181, v181, v4
    v_mul_f32 v182, v182, v4
    v_mul_f32 v183, v183, v4
    v_cvt_pk_bf16_f32 v8, v176, v177
    v_cvt_pk_bf16_f32 v9, v178, v179
    v_cvt_pk_bf16_f32 v10, v180, v181
    v_cvt_pk_bf16_f32 v11, v182, v183
    buffer_store_dwordx4 v[8:11], v1, s[4:7], s21 offen offset:0 sc1
    v_mul_f32 v184, v184, v4
    v_mul_f32 v185, v185, v4
    v_mul_f32 v186, v186, v4
    v_mul_f32 v187, v187, v4
    v_mul_f32 v188, v188, v4
    v_mul_f32 v189, v189, v4
    v_mul_f32 v190, v190, v4
    v_mul_f32 v191, v191, v4
    v_cvt_pk_bf16_f32 v12, v184, v185
    v_cvt_pk_bf16_f32 v13, v186, v187
    v_cvt_pk_bf16_f32 v14, v188, v189
    v_cvt_pk_bf16_f32 v15, v190, v191
    buffer_store_dwordx4 v[12:15], v1, s[4:7], s21 offen offset:1024 sc1
    v_mul_f32 v192, v192, v4
    v_mul_f32 v193, v193, v4
    v_mul_f32 v194, v194, v4
    v_mul_f32 v195, v195, v4
    v_mul_f32 v196, v196, v4
    v_mul_f32 v197, v197, v4
    v_mul_f32 v198, v198, v4
    v_mul_f32 v199, v199, v4
    v_cvt_pk_bf16_f32 v8, v192, v193
    v_cvt_pk_bf16_f32 v9, v194, v195
    v_cvt_pk_bf16_f32 v10, v196, v197
    v_cvt_pk_bf16_f32 v11, v198, v199
    buffer_store_dwordx4 v[8:11], v1, s[4:7], s21 offen offset:2048 sc1
    v_mul_f32 v200, v200, v4
    v_mul_f32 v201, v201, v4
    v_mul_f32 v202, v202, v4
    v_mul_f32 v203, v203, v4
    v_mul_f32 v204, v204, v4
    v_mul_f32 v205, v205, v4
    v_mul_f32 v206, v206, v4
    v_mul_f32 v207, v207, v4
    v_cvt_pk_bf16_f32 v12, v200, v201
    v_cvt_pk_bf16_f32 v13, v202, v203
    v_cvt_pk_bf16_f32 v14, v204, v205
    v_cvt_pk_bf16_f32 v15, v206, v207
    buffer_store_dwordx4 v[12:15], v1, s[4:7], s21 offen offset:3072 sc1
    s_add_u32 s21, s21, 131072
    v_cndmask_b32 v160, v160, v2, s[32:33]
    v_cndmask_b32 v161, v161, v2, s[34:35]
    v_cndmask_b32 v162, v162, v2, s[36:37]
    v_cndmask_b32 v163, v163, v2, s[38:39]
    v_max_f32 v4, v152, v153
    v_max3_f32 v4, v4, v154, v155
    v_max3_f32 v4, v4, v156, v157
    v_max3_f32 v4, v4, v158, v159
    v_max3_f32 v4, v4, v160, v161
    v_max3_f32 v4, v4, v162, v163
    v_mov_b32 v5, v4
    s_nop 1
    v_permlane32_swap_b32 v5, v4
    v_max_f32 v4, v4, v5
    v_mov_b32 v5, v4
    s_nop 1
    v_permlane16_swap_b32 v5, v4
    v_max_f32 v4, v4, v5
    v_mul_f32 v5, 0xbe0293ee, v4
    v_fma_f32 v152, v152, s30, v5
    v_fma_f32 v153, v153, s30, v5
    v_fma_f32 v154, v154, s30, v5
    v_fma_f32 v155, v155, s30, v5
    v_fma_f32 v156, v156, s30, v5
    v_fma_f32 v157, v157, s30, v5
    v_fma_f32 v158, v158, s30, v5
    v_fma_f32 v159, v159, s30, v5
    v_fma_f32 v160, v160, s30, v5
    v_fma_f32 v161, v161, s30, v5
    v_fma_f32 v162, v162, s30, v5
    v_fma_f32 v163, v163, s30, v5
    v_exp_f32 v152, v152
    v_exp_f32 v153, v153
    v_exp_f32 v154, v154
    v_exp_f32 v155, v155
    v_exp_f32 v156, v156
    v_exp_f32 v157, v157
    v_exp_f32 v158, v158
    v_exp_f32 v159, v159
    v_exp_f32 v160, v160
    v_exp_f32 v161, v161
    v_exp_f32 v162, v162
    v_exp_f32 v163, v163
    v_mov_b64 v[168:169], 0
    v_cvt_pk_bf16_f32 v164, v152, v153
    v_cvt_pk_bf16_f32 v165, v154, v155
    v_cvt_pk_bf16_f32 v166, v156, v157
    v_cvt_pk_bf16_f32 v167, v158, v159
    v_cvt_pk_bf16_f32 v168, v160, v161
    v_cvt_pk_bf16_f32 v169, v162, v163
    v_add_f32 v4, v152, v153
    v_add_f32 v5, v154, v155
    v_add_f32 v4, v4, v5
    v_mul_f32 v4, 0.5, v4
    v_mfma_f32_16x16x32_bf16 v[176:179], v[24:27], v[166:169], 0
    v_mfma_f32_16x16x32_bf16 v[180:183], v[28:31], v[166:169], 0
    v_mfma_f32_16x16x32_bf16 v[184:187], v[40:43], v[166:169], 0
    v_mfma_f32_16x16x32_bf16 v[188:191], v[44:47], v[166:169], 0
    v_mfma_f32_16x16x32_bf16 v[192:195], v[56:59], v[166:169], 0
    v_mfma_f32_16x16x32_bf16 v[196:199], v[60:63], v[166:169], 0
    v_mfma_f32_16x16x32_bf16 v[200:203], v[72:75], v[166:169], 0
    v_mfma_f32_16x16x32_bf16 v[204:207], v[76:79], v[166:169], 0
    v_mfma_f32_16x16x16_bf16 v[176:179], v[116:117], v[164:165], v[176:179]
    v_mfma_f32_16x16x16_bf16 v[180:183], v[118:119], v[164:165], v[180:183]
    v_mfma_f32_16x16x16_bf16 v[184:187], v[124:125], v[164:165], v[184:187]
    v_mfma_f32_16x16x16_bf16 v[188:191], v[126:127], v[164:165], v[188:191]
    v_mfma_f32_16x16x16_bf16 v[192:195], v[132:133], v[164:165], v[192:195]
    v_mfma_f32_16x16x16_bf16 v[196:199], v[134:135], v[164:165], v[196:199]
    v_mfma_f32_16x16x16_bf16 v[200:203], v[140:141], v[164:165], v[200:203]
    v_mfma_f32_16x16x16_bf16 v[204:207], v[142:143], v[164:165], v[204:207]
    v_add_f32 v4, v4, v156
    v_add_f32 v4, v4, v157
    v_add_f32 v4, v4, v158
    v_add_f32 v4, v4, v159
    v_add_f32 v4, v4, v160
    v_add_f32 v4, v4, v161
    v_add_f32 v4, v4, v162
    v_add_f32 v4, v4, v163
    v_mov_b32 v5, v4
    s_nop 1
    v_permlane32_swap_b32 v5, v4
    v_add_f32 v4, v4, v5
    v_mov_b32 v5, v4
    s_nop 1
    v_permlane16_swap_b32 v5, v4
    v_add_f32 v4, v4, v5
    v_rcp_f32 v4, v4
    s_nop 0
    v_mul_f32 v176, v176, v4
    v_mul_f32 v177, v177, v4
    v_mul_f32 v178, v178, v4
    v_mul_f32 v179, v179, v4
    v_mul_f32 v180, v180, v4
    v_mul_f32 v181, v181, v4
    v_mul_f32 v182, v182, v4
    v_mul_f32 v183, v183, v4
    v_cvt_pk_bf16_f32 v8, v176, v177
    v_cvt_pk_bf16_f32 v9, v178, v179
    v_cvt_pk_bf16_f32 v10, v180, v181
    v_cvt_pk_bf16_f32 v11, v182, v183
    buffer_store_dwordx4 v[8:11], v1, s[4:7], s21 offen offset:0 sc1
    v_mul_f32 v184, v184, v4
    v_mul_f32 v185, v185, v4
    v_mul_f32 v186, v186, v4
    v_mul_f32 v187, v187, v4
    v_mul_f32 v188, v188, v4
    v_mul_f32 v189, v189, v4
    v_mul_f32 v190, v190, v4
    v_mul_f32 v191, v191, v4
    v_cvt_pk_bf16_f32 v12, v184, v185
    v_cvt_pk_bf16_f32 v13, v186, v187
    v_cvt_pk_bf16_f32 v14, v188, v189
    v_cvt_pk_bf16_f32 v15, v190, v191
    buffer_store_dwordx4 v[12:15], v1, s[4:7], s21 offen offset:1024 sc1
    v_mul_f32 v192, v192, v4
    v_mul_f32 v193, v193, v4
    v_mul_f32 v194, v194, v4
    v_mul_f32 v195, v195, v4
    v_mul_f32 v196, v196, v4
    v_mul_f32 v197, v197, v4
    v_mul_f32 v198, v198, v4
    v_mul_f32 v199, v199, v4
    v_cvt_pk_bf16_f32 v8, v192, v193
    v_cvt_pk_bf16_f32 v9, v194, v195
    v_cvt_pk_bf16_f32 v10, v196, v197
    v_cvt_pk_bf16_f32 v11, v198, v199
    buffer_store_dwordx4 v[8:11], v1, s[4:7], s21 offen offset:2048 sc1
    v_mul_f32 v200, v200, v4
    v_mul_f32 v201, v201, v4
    v_mul_f32 v202, v202, v4
    v_mul_f32 v203, v203, v4
    v_mul_f32 v204, v204, v4
    v_mul_f32 v205, v205, v4
    v_mul_f32 v206, v206, v4
    v_mul_f32 v207, v207, v4
    v_cvt_pk_bf16_f32 v12, v200, v201
    v_cvt_pk_bf16_f32 v13, v202, v203
    v_cvt_pk_bf16_f32 v14, v204, v205
    v_cvt_pk_bf16_f32 v15, v206, v207
    buffer_store_dwordx4 v[12:15], v1, s[4:7], s21 offen offset:3072 sc1
    s_add_u32 s21, s21, 131072
    s_lshl_b32 s12, s40, 7
    s_add_u32 s12, s12, 47128576
    s_waitcnt vmcnt(0)
    s_mov_b64 exec, 1
    v_mov_b32 v5, 1
    buffer_atomic_add v5, off, s[4:7], s12 sc1
    s_mov_b64 exec, -1
    s_add_u32 s40, s40, 7
    s_cmp_lt_u32 s40, 64
    s_cbranch_scc1 attn_loop
w_end:
    s_endpgm
.section .rodata,"a"
.p2align 6
.amdhsa_kernel prep_kernel
  .amdhsa_next_free_vgpr 104
  .amdhsa_next_free_sgpr 96
  .amdhsa_accum_offset 104
  .amdhsa_group_segment_fixed_size 0
  .amdhsa_kernarg_size 112
  .amdhsa_user_sgpr_count 2
  .amdhsa_user_sgpr_kernarg_segment_ptr 1
  .amdhsa_system_sgpr_workgroup_id_x 1
.end_amdhsa_kernel
.section .rodata,"a"
.p2align 6
.amdhsa_kernel rec_kernel
  .amdhsa_next_free_vgpr 512
  .amdhsa_next_free_sgpr 96
  .amdhsa_accum_offset 256
  .amdhsa_group_segment_fixed_size 0
  .amdhsa_kernarg_size 112
  .amdhsa_user_sgpr_count 2
  .amdhsa_user_sgpr_kernarg_segment_ptr 1
  .amdhsa_system_sgpr_workgroup_id_x 1
.end_amdhsa_kernel
```
